```python
import torch

def _softmax(x, axis=-1):
    return torch.softmax(x, dim=axis)
def _gelu(x):
    return torch.nn.functional.gelu(x, approximate="tanh")
def _silu(x):
    return torch.nn.functional.silu(x)
def _sigmoid(x):
    return torch.sigmoid(x)
def _layernorm(x, axis=-1, eps=1e-5):
    m = x.mean(dim=axis, keepdim=True)
    v = x.var(dim=axis, keepdim=True, unbiased=False)
    return (x - m) / torch.sqrt(v + eps)
def _scatter_add(tgt, idx, src, axis=0):
    return tgt.clone().index_add_(axis, idx, src)
def _segment_sum(src, seg, n):
    out = torch.zeros((n,) + src.shape[1:], dtype=src.dtype)
    return out.index_add_(0, seg, src)
def _pad(x, pw):
    flat = tuple(v for pair in reversed(pw) for v in pair)
    return torch.nn.functional.pad(x, flat)

kernel_name = 'parallel_sum__compressed_kv_cla__glu_gated_reglu__prompt'

def setup_inputs():

    _w = (lambda a: (lambda t: t.to(torch.bfloat16) if t.is_floating_point() else t)(torch.as_tensor(a)))
    def _A_setup():
        B, H, Sq, Sk, D, M = 1, 32, 2048, 2048, 128, 640
        Dc = 4 * D
        return {
            "x": _w((lambda *s: torch.randn(*s, dtype=torch.bfloat16) * 0.05)(B, Sq, M)),
            "c_kv": _w((lambda *s: torch.randn(*s, dtype=torch.bfloat16) * 0.4)(B, Sk, Dc)),
            "w_q": _w((lambda *s: torch.randn(*s, dtype=torch.bfloat16) * 1.6)(M, H, D) * (M ** -0.5)),
            "w_uk": _w((lambda *s: torch.randn(*s, dtype=torch.bfloat16) * 1.6)(Dc, H, D) * (Dc ** -0.5)),
            "w_uv": _w((lambda *s: torch.randn(*s, dtype=torch.bfloat16) * 0.4)(Dc, H, D) * (Dc ** -0.5)),
            "w_o": _w((lambda *s: torch.randn(*s, dtype=torch.bfloat16) * 0.4)(H, D, M) * ((H * D) ** -0.5)),
        }
    _A_in = _A_setup()

    def _B_setup():
        B, S, D, F = 1, 2048, 640, 1728
        return {
            "x": _w((lambda *s: torch.randn(*s, dtype=torch.bfloat16) * 0.05)(B, S, D)),
            "W_gate": _w((lambda *s: torch.randn(*s, dtype=torch.bfloat16) * 0.2)(D, F) * (2.0 / D) ** 0.5),
            "W_up": _w((lambda *s: torch.randn(*s, dtype=torch.bfloat16) * 0.2)(D, F) * (2.0 / D) ** 0.5),
            "W_down": _w((lambda *s: torch.randn(*s, dtype=torch.bfloat16) * 0.2)(F, D) * (1.0 / F) ** 0.5),
        }
    _B_in = _B_setup()

    return {
        "A_x": _A_in["x"],
        "A_c_kv": _A_in["c_kv"],
        "A_w_q": _A_in["w_q"],
        "A_w_uk": _A_in["w_uk"],
        "A_w_uv": _A_in["w_uv"],
        "A_w_o": _A_in["w_o"],
        "B_x": _B_in["x"],
        "B_W_gate": _B_in["W_gate"],
        "B_W_up": _B_in["W_up"],
        "B_W_down": _B_in["W_down"],
    }

def reference(A_x, A_c_kv, A_w_q, A_w_uk, A_w_uv, A_w_o, B_x, B_W_gate, B_W_up, B_W_down):
    def _A_ref(x, c_kv, w_q, w_uk, w_uv, w_o):
        B, Sq, M = x.shape[0], x.shape[1], x.shape[2]
        Sk = c_kv.shape[1]
        H, D = w_q.shape[1], w_q.shape[2]
        q = torch.einsum("bqm,mhd->bhqd", x, w_q)
        k = torch.einsum("bkc,chd->bhkd", c_kv, w_uk)
        v = torch.einsum("bkc,chd->bhkd", c_kv, w_uv)
        scores = torch.einsum("bhqd,bhkd->bhqk", q, k) * (D ** -0.5)
        off = Sk - Sq
        qi = torch.arange(Sq)[:, None]
        kj = torch.arange(Sk)[None, :]
        cmask = kj <= (qi + off)
        scores = torch.where(cmask[None, None], scores, -1e9)
        p = _softmax(scores, axis=-1)
        ctx = torch.einsum("bhqk,bhkd->bhqd", p, v)
        return torch.einsum("bhqd,hdm->bqm", ctx, w_o)

    def _B_ref(x, W_gate, W_up, W_down):
        gate = torch.einsum("bsd,df->bsf", x, W_gate)
        up = torch.einsum("bsd,df->bsf", x, W_up)
        gate = gate * (lambda x, dt: x.to(dt))(gate > 0, gate.dtype)
        h = gate * up
        return torch.einsum("bsf,fd->bsd", h, W_down)

    x = A_x
    xn = _layernorm(x, axis=-1)
    return x + _A_ref(xn, A_c_kv, A_w_q, A_w_uk, A_w_uv, A_w_o) + _B_ref(xn, B_W_gate, B_W_up, B_W_down)
```

```asm
; @launch kernel=k1_kernel grid=(256,1,1) block=(512,1,1) lds=131072
; @launch kernel=k2_kernel grid=(256,1,1) block=(512,1,1) lds=163840
; @launch kernel=k3_kernel grid=(256,1,1) block=(768,1,1) lds=147456
.amdgcn_target "amdgcn-amd-amdhsa--gfx950"
.text
.p2align 8
.globl k1_kernel
.type k1_kernel,@function
k1_kernel:
    s_cmp_ge_u32 s2, 256
    s_cbranch_scc1 K1_DONE
    v_and_b32 v190, 63, v0
    v_lshrrev_b32 v191, 6, v0
    s_nop 0
    v_readfirstlane_b32 s21, v191
    s_and_b32 s3, s2, 7
    s_lshr_b32 s4, s2, 3
    s_and_b32 s22, s4, 3
    s_lshl_b32 s3, s3, 2
    s_add_u32 s22, s22, s3
    s_lshr_b32 s23, s4, 2
    s_load_dwordx4 s[24:27], s[0:1], 0
    s_load_dwordx4 s[28:31], s[0:1], 24
    s_load_dwordx2 s[52:53], s[0:1], 16
    s_load_dwordx4 s[56:59], s[0:1], 56
    s_load_dwordx2 s[36:37], s[0:1], 96
    s_bitcmp1_b32 s21, 1
    s_cselect_b64 vcc, -1, 0
    s_cselect_b32 s4, 4, 2
    v_and_b32 v191, 15, v190
    v_lshrrev_b32 v193, 4, v190
    v_bfe_u32 v194, v190, 4, 1
    v_and_b32 v192, 3, v191
    v_bfe_u32 v195, v191, 2, 1
    v_lshl_or_b32 v192, v195, 3, v192
    v_bfe_u32 v195, v191, 3, 1
    v_lshl_or_b32 v191, v195, s4, v192
    v_lshrrev_b32 v192, 5, v190
    v_lshl_or_b32 v192, v194, 1, v192
    v_cndmask_b32 v193, v193, v192, vcc
    v_bfe_u32 v192, v191, 1, 3
    v_xor_b32 v192, v192, v193
    v_lshlrev_b32 v192, 4, v192
    v_lshl_or_b32 v192, v191, 7, v192
    s_lshr_b32 s3, s21, 2
    s_lshl_b32 s3, s3, 14
    v_add_u32 v176, s3, v192
    v_bfe_u32 v191, v190, 2, 2
    v_lshl_add_u32 v192, v193, 3, v191
    v_lshlrev_b32 v195, 7, v192
    v_bfe_u32 v192, v190, 3, 1
    v_lshl_or_b32 v195, v192, 6, v195
    v_and_b32 v191, 3, v190
    v_and_b32 v192, 1, v190
    v_xor_b32 v193, v191, v194
    v_lshlrev_b32 v193, 1, v193
    v_or_b32 v193, v193, v192
    v_lshl_or_b32 v195, v193, 3, v195
    s_and_b32 s3, s21, 3
    s_lshl_b32 s3, s3, 13
    s_add_u32 s3, s3, 0x10000
    v_add_u32 v180, s3, v195
    v_xor_b32 v181, 64, v180
    s_lshl_b32 s5, s23, 8
    s_lshl_b32 s6, s21, 5
    s_add_u32 s5, s5, s6
    s_mov_b32 s6, 8192
    s_bfe_u32 s7, s21, 0x10001
    s_lshl_b32 s7, s7, 7
    s_lshl_b32 s38, s22, 8
    s_add_u32 s7, s7, s38
    v_lshrrev_b32 v191, 3, v190
    v_and_b32 v192, 7, v190
    v_lshrrev_b32 v193, 4, v190
    v_xor_b32 v193, v192, v193
    v_add_u32 v194, s5, v191
    s_mov_b32 s3, 1024
    v_mul_lo_u32 v194, v194, s3
    v_lshl_add_u32 v182, v193, 4, v194
    v_xor_b32 v196, 4, v193
    v_lshl_add_u32 v183, v196, 4, v194
    v_add_u32 v183, 7168, v183
    v_lshl_add_u32 v184, v193, 4, v194
    v_add_u32 v184, 14336, v184
    v_xor_b32 v196, 4, v193
    v_lshl_add_u32 v185, v196, 4, v194
    v_add_u32 v185, 21504, v185
    v_bfe_u32 v193, v190, 4, 1
    v_lshlrev_b32 v193, 2, v193
    v_xor_b32 v193, v192, v193
    s_and_b32 s3, s21, 1
    s_lshl_b32 s3, s3, 5
    v_add_u32 v194, s3, v191
    v_mul_lo_u32 v194, v194, s6
    v_lshl_add_u32 v194, v193, 4, v194
    v_add_u32 v186, s7, v194
    s_lshl_b32 s3, s6, 3
    s_sub_u32 s3, s3, 1024
    v_add_u32 v187, s3, v186
    v_add_u32 v188, s3, v187
    v_add_u32 v189, s3, v188
    s_cmp_lt_u32 s21, 4
    s_cselect_b32 s3, 16, 0
    v_xor_b32 v187, s3, v187
    s_cselect_b32 s3, 0, 16
    v_xor_b32 v188, s3, v188
    s_cselect_b32 s3, 16, 16
    v_xor_b32 v189, s3, v189
    s_lshl_b32 s18, s6, 6
    s_lshr_b32 s3, s2, 3
    s_lshl_b32 s3, s3, 3
    s_add_u32 s3, s3, s21
    s_lshl_b32 s3, s3, 3
    v_bfe_u32 v191, v190, 2, 3
    v_add_u32 v191, s3, v191
    v_mul_u32_u24 v191, 1024, v191
    v_and_b32 v192, 3, v190
    v_lshl_add_u32 v198, v192, 6, v191
    s_and_b32 s3, s21, 1
    s_lshl_b32 s4, s23, 1
    s_add_u32 s3, s3, s4
    s_lshl_b32 s3, s3, 3
    s_add_u32 s3, s3, 64
    v_bfe_u32 v191, v190, 1, 3
    v_add_u32 v191, s3, v191
    v_mul_lo_u32 v191, v191, s6
    v_and_b32 v192, 1, v190
    v_lshl_add_u32 v191, v192, 6, v191
    v_add_u32 v199, s7, v191
    s_lshl_b32 s19, s21, 12
    s_add_u32 s20, s19, 0x10000
    s_mov_b32 s16, 0
    s_mov_b32 s17, 0
    s_waitcnt lgkmcnt(0)
    s_mov_b32 s8, s26
    s_and_b32 s9, s27, 0xffff
    s_mov_b32 s10, 2097152
    s_mov_b32 s11, 0x20000
    s_cmp_lt_u32 s21, 4
    s_cselect_b32 s38, s28, s30
    s_cselect_b32 s39, s29, s31
    s_mov_b32 s12, s38
    s_and_b32 s13, s39, 0xffff
    s_mov_b32 s14, 4194304
    s_mov_b32 s15, 0x20000
    s_add_u32 m0, s19, 0
    s_nop 0
    buffer_load_dwordx4 v182, s[8:11], s16 offen offset:0 lds
    buffer_load_dwordx4 v183, s[8:11], s16 offen offset:1024 lds
    buffer_load_dwordx4 v184, s[8:11], s16 offen offset:2048 lds
    buffer_load_dwordx4 v185, s[8:11], s16 offen offset:3072 lds
    s_add_u32 m0, s20, 0
    s_add_u32 s16, s16, 128
    buffer_load_dwordx4 v186, s[12:15], s17 offen offset:0 lds
    buffer_load_dwordx4 v187, s[12:15], s17 offen offset:1024 lds
    buffer_load_dwordx4 v188, s[12:15], s17 offen offset:2048 lds
    buffer_load_dwordx4 v189, s[12:15], s17 offen offset:3072 lds
    s_add_u32 s17, s17, s18
    s_lshl_b32 s40, s2, 3
    s_add_u32 s40, s40, s21
    s_mov_b32 s44, s24
    s_and_b32 s45, s25, 0xffff
    s_mov_b32 s46, 2621440
    s_mov_b32 s47, 0x20000
    s_mul_i32 s41, s40, 1280
    v_lshlrev_b32 v200, 2, v190
    buffer_load_dword v201, v200, s[44:47], s41 offen offset:0
    buffer_load_dword v202, v200, s[44:47], s41 offen offset:256
    buffer_load_dword v203, v200, s[44:47], s41 offen offset:512
    buffer_load_dword v204, v200, s[44:47], s41 offen offset:768
    buffer_load_dword v205, v200, s[44:47], s41 offen offset:1024
    s_add_u32 m0, s19, 32768
    s_nop 0
    buffer_load_dwordx4 v182, s[8:11], s16 offen offset:0 lds
    buffer_load_dwordx4 v183, s[8:11], s16 offen offset:1024 lds
    buffer_load_dwordx4 v184, s[8:11], s16 offen offset:2048 lds
    buffer_load_dwordx4 v185, s[8:11], s16 offen offset:3072 lds
    s_add_u32 s16, s16, 128
    s_waitcnt vmcnt(4)
    v_lshlrev_b32 v230, 16, v201
    v_and_b32 v231, 0xffff0000, v201
    v_lshlrev_b32 v232, 16, v202
    v_and_b32 v233, 0xffff0000, v202
    v_lshlrev_b32 v234, 16, v203
    v_and_b32 v235, 0xffff0000, v203
    v_lshlrev_b32 v236, 16, v204
    v_and_b32 v237, 0xffff0000, v204
    v_lshlrev_b32 v238, 16, v205
    v_and_b32 v239, 0xffff0000, v205
    v_add_f32 v240, v230, v231
    v_add_f32 v240, v240, v232
    v_add_f32 v240, v240, v233
    v_add_f32 v240, v240, v234
    v_add_f32 v240, v240, v235
    v_add_f32 v240, v240, v236
    v_add_f32 v240, v240, v237
    v_add_f32 v240, v240, v238
    v_add_f32 v240, v240, v239
    s_nop 1
    v_add_f32_dpp v240, v240, v240 row_ror:8 row_mask:0xf bank_mask:0xf
    s_nop 1
    v_add_f32_dpp v240, v240, v240 row_ror:4 row_mask:0xf bank_mask:0xf
    s_nop 1
    v_add_f32_dpp v240, v240, v240 row_ror:2 row_mask:0xf bank_mask:0xf
    s_nop 1
    v_add_f32_dpp v240, v240, v240 row_ror:1 row_mask:0xf bank_mask:0xf
    v_mov_b32 v241, v240
    s_nop 1
    v_permlane16_swap_b32 v240, v241
    v_add_f32 v240, v240, v241
    v_mov_b32 v241, v240
    s_nop 1
    v_permlane32_swap_b32 v240, v241
    v_add_f32 v240, v240, v241
    v_mul_f32 v240, 0x3acccccd, v240
    v_sub_f32 v242, v230, v240
    v_mul_f32 v243, v242, v242
    v_sub_f32 v242, v231, v240
    v_fmac_f32 v243, v242, v242
    v_sub_f32 v242, v232, v240
    v_fmac_f32 v243, v242, v242
    v_sub_f32 v242, v233, v240
    v_fmac_f32 v243, v242, v242
    v_sub_f32 v242, v234, v240
    v_fmac_f32 v243, v242, v242
    v_sub_f32 v242, v235, v240
    v_fmac_f32 v243, v242, v242
    v_sub_f32 v242, v236, v240
    v_fmac_f32 v243, v242, v242
    v_sub_f32 v242, v237, v240
    v_fmac_f32 v243, v242, v242
    v_sub_f32 v242, v238, v240
    v_fmac_f32 v243, v242, v242
    v_sub_f32 v242, v239, v240
    v_fmac_f32 v243, v242, v242
    s_nop 1
    v_add_f32_dpp v243, v243, v243 row_ror:8 row_mask:0xf bank_mask:0xf
    s_nop 1
    v_add_f32_dpp v243, v243, v243 row_ror:4 row_mask:0xf bank_mask:0xf
    s_nop 1
    v_add_f32_dpp v243, v243, v243 row_ror:2 row_mask:0xf bank_mask:0xf
    s_nop 1
    v_add_f32_dpp v243, v243, v243 row_ror:1 row_mask:0xf bank_mask:0xf
    v_mov_b32 v241, v243
    s_nop 1
    v_permlane16_swap_b32 v243, v241
    v_add_f32 v243, v243, v241
    v_mov_b32 v241, v243
    s_nop 1
    v_permlane32_swap_b32 v243, v241
    v_add_f32 v243, v243, v241
    v_mul_f32 v243, 0x3acccccd, v243
    v_cvt_pk_bf16_f32 v240, v240, v240
    v_and_b32 v240, 0xffff0000, v240
    v_cvt_pk_bf16_f32 v243, v243, v243
    v_and_b32 v243, 0xffff0000, v243
    v_add_f32 v243, 0x3727c5ac, v243
    v_cvt_pk_bf16_f32 v243, v243, v243
    v_and_b32 v243, 0xffff0000, v243
    v_sqrt_f32 v243, v243
    s_nop 0
    v_cvt_pk_bf16_f32 v243, v243, v243
    v_and_b32 v243, 0xffff0000, v243
    v_rcp_f32 v243, v243
    v_sub_f32 v230, v230, v240
    v_sub_f32 v231, v231, v240
    v_cvt_pk_bf16_f32 v201, v230, v231
    v_lshlrev_b32 v230, 16, v201
    v_and_b32 v231, 0xffff0000, v201
    v_mul_f32 v230, v230, v243
    v_mul_f32 v231, v231, v243
    v_cvt_pk_bf16_f32 v201, v230, v231
    v_sub_f32 v232, v232, v240
    v_sub_f32 v233, v233, v240
    v_cvt_pk_bf16_f32 v202, v232, v233
    v_lshlrev_b32 v232, 16, v202
    v_and_b32 v233, 0xffff0000, v202
    v_mul_f32 v232, v232, v243
    v_mul_f32 v233, v233, v243
    v_cvt_pk_bf16_f32 v202, v232, v233
    v_sub_f32 v234, v234, v240
    v_sub_f32 v235, v235, v240
    v_cvt_pk_bf16_f32 v203, v234, v235
    v_lshlrev_b32 v234, 16, v203
    v_and_b32 v235, 0xffff0000, v203
    v_mul_f32 v234, v234, v243
    v_mul_f32 v235, v235, v243
    v_cvt_pk_bf16_f32 v203, v234, v235
    v_sub_f32 v236, v236, v240
    v_sub_f32 v237, v237, v240
    v_cvt_pk_bf16_f32 v204, v236, v237
    v_lshlrev_b32 v236, 16, v204
    v_and_b32 v237, 0xffff0000, v204
    v_mul_f32 v236, v236, v243
    v_mul_f32 v237, v237, v243
    v_cvt_pk_bf16_f32 v204, v236, v237
    v_sub_f32 v238, v238, v240
    v_sub_f32 v239, v239, v240
    v_cvt_pk_bf16_f32 v205, v238, v239
    v_lshlrev_b32 v238, 16, v205
    v_and_b32 v239, 0xffff0000, v205
    v_mul_f32 v238, v238, v243
    v_mul_f32 v239, v239, v243
    v_cvt_pk_bf16_f32 v205, v238, v239
    s_mov_b32 s44, s36
    s_and_b32 s45, s37, 0xffff
    s_mov_b32 s46, 2621440
    s_mov_b32 s47, 0x20000
    buffer_store_dword v201, v200, s[44:47], s41 offen offset:0
    buffer_store_dword v202, v200, s[44:47], s41 offen offset:256
    buffer_store_dword v203, v200, s[44:47], s41 offen offset:512
    buffer_store_dword v204, v200, s[44:47], s41 offen offset:768
    buffer_store_dword v205, v200, s[44:47], s41 offen offset:1024
    s_add_u32 s48, s36, 3145728
    s_addc_u32 s49, s37, 0
    s_and_b32 s49, s49, 0xffff
    s_mov_b32 s50, 16384
    s_mov_b32 s51, 0x20000
    s_lshl_b32 s42, s40, 8
    v_mov_b32 v208, 0
    buffer_store_dword v208, v200, s[48:51], s42 offen
    s_and_b32 s3, s21, 2
    s_cmp_eq_u32 s3, 0
    s_mov_b32 s38, 20971520
    s_cselect_b32 s38, 4194304, s38
    s_lshl_b32 s39, s22, 19
    s_add_u32 s38, s38, s39
    s_add_u32 s44, s36, s38
    s_addc_u32 s45, s37, 0
    s_and_b32 s45, s45, 0xffff
    s_mov_b32 s46, 524288
    s_mov_b32 s47, 0x20000
    s_cmp_lt_u32 s21, 5
    s_cselect_b32 s56, s56, s58
    s_cselect_b32 s57, s57, s59
    s_cselect_b32 s5, 3, 5
    s_cmp_lt_u32 s21, 3
    s_cselect_b32 s56, s52, s56
    s_cselect_b32 s57, s53, s57
    s_cselect_b32 s5, 0, s5
    s_cselect_b32 s6, 3, 2
    s_mov_b32 s7, 3456
    s_cselect_b32 s7, 8192, s7
    s_mul_i32 s60, s7, 640
    s_mov_b32 s48, s56
    s_and_b32 s49, s57, 0xffff
    s_mov_b32 s50, 0
    s_mov_b32 s51, 0x20000
    s_sub_u32 s5, s21, s5
    s_lshl_b32 s5, s5, 6
    v_add_u32 v250, s5, v190
    v_lshrrev_b32 v251, s6, v250
    v_lshlrev_b32 v252, s6, v251
    v_sub_u32 v250, v250, v252
    v_mul_lo_u32 v251, v251, s7
    v_lshl_add_u32 v250, v250, 7, v251
    s_lshr_b32 s38, s2, 3
    s_mul_i32 s38, s38, 20
    s_mul_i32 s38, s38, s7
    s_and_b32 s39, s2, 7
    s_add_u32 s6, s6, 7
    s_lshl_b32 s39, s39, s6
    s_add_u32 s61, s38, s39
    s_lshl_b32 s62, s21, 2
    s_lshr_b32 s62, 0x02323232, s62
    s_and_b32 s62, s62, 15
    v_mov_b64 v[0:1], 0
    v_mov_b64 v[2:3], 0
    v_mov_b64 v[4:5], 0
    v_mov_b64 v[6:7], 0
    v_mov_b64 v[8:9], 0
    v_mov_b64 v[10:11], 0
    v_mov_b64 v[12:13], 0
    v_mov_b64 v[14:15], 0
    v_mov_b64 v[16:17], 0
    v_mov_b64 v[18:19], 0
    v_mov_b64 v[20:21], 0
    v_mov_b64 v[22:23], 0
    v_mov_b64 v[24:25], 0
    v_mov_b64 v[26:27], 0
    v_mov_b64 v[28:29], 0
    v_mov_b64 v[30:31], 0
    v_mov_b64 v[32:33], 0
    v_mov_b64 v[34:35], 0
    v_mov_b64 v[36:37], 0
    v_mov_b64 v[38:39], 0
    v_mov_b64 v[40:41], 0
    v_mov_b64 v[42:43], 0
    v_mov_b64 v[44:45], 0
    v_mov_b64 v[46:47], 0
    v_mov_b64 v[48:49], 0
    v_mov_b64 v[50:51], 0
    v_mov_b64 v[52:53], 0
    v_mov_b64 v[54:55], 0
    v_mov_b64 v[56:57], 0
    v_mov_b64 v[58:59], 0
    v_mov_b64 v[60:61], 0
    v_mov_b64 v[62:63], 0
    v_mov_b64 v[64:65], 0
    v_mov_b64 v[66:67], 0
    v_mov_b64 v[68:69], 0
    v_mov_b64 v[70:71], 0
    v_mov_b64 v[72:73], 0
    v_mov_b64 v[74:75], 0
    v_mov_b64 v[76:77], 0
    v_mov_b64 v[78:79], 0
    v_mov_b64 v[80:81], 0
    v_mov_b64 v[82:83], 0
    v_mov_b64 v[84:85], 0
    v_mov_b64 v[86:87], 0
    v_mov_b64 v[88:89], 0
    v_mov_b64 v[90:91], 0
    v_mov_b64 v[92:93], 0
    v_mov_b64 v[94:95], 0
    v_mov_b64 v[96:97], 0
    v_mov_b64 v[98:99], 0
    v_mov_b64 v[100:101], 0
    v_mov_b64 v[102:103], 0
    v_mov_b64 v[104:105], 0
    v_mov_b64 v[106:107], 0
    v_mov_b64 v[108:109], 0
    v_mov_b64 v[110:111], 0
    v_mov_b64 v[112:113], 0
    v_mov_b64 v[114:115], 0
    v_mov_b64 v[116:117], 0
    v_mov_b64 v[118:119], 0
    v_mov_b64 v[120:121], 0
    v_mov_b64 v[122:123], 0
    v_mov_b64 v[124:125], 0
    v_mov_b64 v[126:127], 0
    s_waitcnt vmcnt(17)
    s_barrier
    s_and_b32 s3, s21, 2
    s_cmp_eq_u32 s3, 0
    s_cbranch_scc0 K1_V
    v_xor_b32 v177, 2048, v176
    v_xor_b32 v178, 64, v176
    v_xor_b32 v179, 2112, v176
    v_xor_b32 v224, 8, v180
    v_xor_b32 v225, 8, v181
    ds_read_b64_tr_b16 v[160:161], v180 offset:0
    ds_read_b64_tr_b16 v[162:163], v180 offset:512
    ds_read_b128 v[128:131], v176 offset:0
    ds_read_b128 v[132:135], v177 offset:0
    ds_read_b64_tr_b16 v[164:165], v224 offset:0
    ds_read_b64_tr_b16 v[166:167], v224 offset:512
    ds_read_b64_tr_b16 v[168:169], v181 offset:0
    ds_read_b64_tr_b16 v[170:171], v181 offset:512
    ds_read_b128 v[136:139], v176 offset:4096
    ds_read_b128 v[140:143], v177 offset:4096
    ds_read_b64_tr_b16 v[172:173], v225 offset:0
    ds_read_b64_tr_b16 v[174:175], v225 offset:512
    buffer_load_dword v197, v198, s[8:11], s16 offen
    buffer_load_dword v197, v199, s[12:15], s17 offen
    s_mov_b32 s69, 4
K1_G0:
    s_cmp_eq_u32 s69, 1
    s_cselect_b32 s10, 0, s10
    s_cmp_eq_u32 s69, s62
    s_cselect_b32 s50, s60, 0
    s_waitcnt lgkmcnt(0)
    v_mfma_f32_16x16x32_bf16 v[0:3], v[160:163], v[128:131], v[0:3]
    s_add_u32 m0, s20, 32768
    v_mfma_f32_16x16x32_bf16 v[8:11], v[160:163], v[132:135], v[8:11]
    ds_read_b64_tr_b16 v[208:209], v180 offset:4096
    v_mfma_f32_16x16x32_bf16 v[32:35], v[160:163], v[136:139], v[32:35]
    buffer_load_dwordx4 v186, s[12:15], s17 offen offset:0 lds
    v_mfma_f32_16x16x32_bf16 v[40:43], v[160:163], v[140:143], v[40:43]
    ds_read_b64_tr_b16 v[210:211], v180 offset:4608
    v_mfma_f32_16x16x32_bf16 v[4:7], v[164:167], v[128:131], v[4:7]
    ds_read_b128 v[144:147], v176 offset:8192
    v_mfma_f32_16x16x32_bf16 v[12:15], v[164:167], v[132:135], v[12:15]
    buffer_load_dwordx4 v187, s[12:15], s17 offen offset:1024 lds
    v_mfma_f32_16x16x32_bf16 v[36:39], v[164:167], v[136:139], v[36:39]
    ds_read_b128 v[148:151], v177 offset:8192
    v_mfma_f32_16x16x32_bf16 v[44:47], v[164:167], v[140:143], v[44:47]
    buffer_load_dwordx4 v188, s[12:15], s17 offen offset:2048 lds
    v_mfma_f32_16x16x32_bf16 v[16:19], v[168:171], v[128:131], v[16:19]
    ds_read_b64_tr_b16 v[212:213], v224 offset:4096
    v_mfma_f32_16x16x32_bf16 v[24:27], v[168:171], v[132:135], v[24:27]
    ds_read_b64_tr_b16 v[214:215], v224 offset:4608
    v_mfma_f32_16x16x32_bf16 v[48:51], v[168:171], v[136:139], v[48:51]
    buffer_load_dwordx4 v189, s[12:15], s17 offen offset:3072 lds
    v_mfma_f32_16x16x32_bf16 v[56:59], v[168:171], v[140:143], v[56:59]
    ds_read_b128 v[152:155], v176 offset:12288
    v_mfma_f32_16x16x32_bf16 v[20:23], v[172:175], v[128:131], v[20:23]
    ds_read_b128 v[156:159], v177 offset:12288
    v_mfma_f32_16x16x32_bf16 v[28:31], v[172:175], v[132:135], v[28:31]
    s_add_u32 s17, s17, s18
    v_mfma_f32_16x16x32_bf16 v[52:55], v[172:175], v[136:139], v[52:55]
    s_cmp_eq_u32 s69, 1
    v_mfma_f32_16x16x32_bf16 v[60:63], v[172:175], v[140:143], v[60:63]
    s_cselect_b32 s14, 0, s14
    s_waitcnt lgkmcnt(0)
    v_mfma_f32_16x16x32_bf16 v[64:67], v[160:163], v[144:147], v[64:67]
    ds_read_b64_tr_b16 v[216:217], v181 offset:4096
    v_mfma_f32_16x16x32_bf16 v[72:75], v[160:163], v[148:151], v[72:75]
    ds_read_b64_tr_b16 v[218:219], v181 offset:4608
    v_mfma_f32_16x16x32_bf16 v[96:99], v[160:163], v[152:155], v[96:99]
    v_mfma_f32_16x16x32_bf16 v[104:107], v[160:163], v[156:159], v[104:107]
    ds_read_b128 v[128:131], v178 offset:0
    v_mfma_f32_16x16x32_bf16 v[68:71], v[164:167], v[144:147], v[68:71]
    v_mfma_f32_16x16x32_bf16 v[76:79], v[164:167], v[148:151], v[76:79]
    ds_read_b128 v[132:135], v179 offset:0
    v_mfma_f32_16x16x32_bf16 v[100:103], v[164:167], v[152:155], v[100:103]
    v_mfma_f32_16x16x32_bf16 v[108:111], v[164:167], v[156:159], v[108:111]
    ds_read_b64_tr_b16 v[220:221], v225 offset:4096
    v_mfma_f32_16x16x32_bf16 v[80:83], v[168:171], v[144:147], v[80:83]
    ds_read_b64_tr_b16 v[222:223], v225 offset:4608
    v_mfma_f32_16x16x32_bf16 v[88:91], v[168:171], v[148:151], v[88:91]
    v_mfma_f32_16x16x32_bf16 v[112:115], v[168:171], v[152:155], v[112:115]
    ds_read_b128 v[136:139], v178 offset:4096
    v_mfma_f32_16x16x32_bf16 v[120:123], v[168:171], v[156:159], v[120:123]
    v_mfma_f32_16x16x32_bf16 v[84:87], v[172:175], v[144:147], v[84:87]
    ds_read_b128 v[140:143], v179 offset:4096
    v_mfma_f32_16x16x32_bf16 v[92:95], v[172:175], v[148:151], v[92:95]
    v_mfma_f32_16x16x32_bf16 v[116:119], v[172:175], v[152:155], v[116:119]
    buffer_load_dword v197, v198, s[8:11], s16 offen offset:256
    v_mfma_f32_16x16x32_bf16 v[124:127], v[172:175], v[156:159], v[124:127]
    s_waitcnt lgkmcnt(0)
    v_mfma_f32_16x16x32_bf16 v[0:3], v[208:211], v[128:131], v[0:3]
    ds_read_b128 v[144:147], v178 offset:8192
    v_mfma_f32_16x16x32_bf16 v[8:11], v[208:211], v[132:135], v[8:11]
    v_mfma_f32_16x16x32_bf16 v[32:35], v[208:211], v[136:139], v[32:35]
    v_mfma_f32_16x16x32_bf16 v[40:43], v[208:211], v[140:143], v[40:43]
    ds_read_b128 v[148:151], v179 offset:8192
    v_mfma_f32_16x16x32_bf16 v[4:7], v[212:215], v[128:131], v[4:7]
    v_mfma_f32_16x16x32_bf16 v[12:15], v[212:215], v[132:135], v[12:15]
    v_mfma_f32_16x16x32_bf16 v[36:39], v[212:215], v[136:139], v[36:39]
    ds_read_b128 v[152:155], v178 offset:12288
    v_mfma_f32_16x16x32_bf16 v[44:47], v[212:215], v[140:143], v[44:47]
    v_mfma_f32_16x16x32_bf16 v[16:19], v[216:219], v[128:131], v[16:19]
    v_mfma_f32_16x16x32_bf16 v[24:27], v[216:219], v[132:135], v[24:27]
    ds_read_b128 v[156:159], v179 offset:12288
    v_mfma_f32_16x16x32_bf16 v[48:51], v[216:219], v[136:139], v[48:51]
    v_mfma_f32_16x16x32_bf16 v[56:59], v[216:219], v[140:143], v[56:59]
    v_mfma_f32_16x16x32_bf16 v[20:23], v[220:223], v[128:131], v[20:23]
    buffer_load_dword v253, v250, s[48:51], s61 offen offset:0
    v_mfma_f32_16x16x32_bf16 v[28:31], v[220:223], v[132:135], v[28:31]
    v_mfma_f32_16x16x32_bf16 v[52:55], v[220:223], v[136:139], v[52:55]
    v_mfma_f32_16x16x32_bf16 v[60:63], v[220:223], v[140:143], v[60:63]
    s_waitcnt vmcnt(2) lgkmcnt(0)
    s_barrier
    v_mfma_f32_16x16x32_bf16 v[64:67], v[208:211], v[144:147], v[64:67]
    s_add_u32 m0, s19, 0
    ds_read_b64_tr_b16 v[160:161], v180 offset:32768
    v_mfma_f32_16x16x32_bf16 v[72:75], v[208:211], v[148:151], v[72:75]
    ds_read_b64_tr_b16 v[162:163], v180 offset:33280
    v_mfma_f32_16x16x32_bf16 v[96:99], v[208:211], v[152:155], v[96:99]
    buffer_load_dwordx4 v182, s[8:11], s16 offen offset:0 lds
    v_mfma_f32_16x16x32_bf16 v[104:107], v[208:211], v[156:159], v[104:107]
    ds_read_b128 v[128:131], v176 offset:32768
    v_mfma_f32_16x16x32_bf16 v[68:71], v[212:215], v[144:147], v[68:71]
    ds_read_b128 v[132:135], v177 offset:32768
    v_mfma_f32_16x16x32_bf16 v[76:79], v[212:215], v[148:151], v[76:79]
    buffer_load_dwordx4 v183, s[8:11], s16 offen offset:1024 lds
    v_mfma_f32_16x16x32_bf16 v[100:103], v[212:215], v[152:155], v[100:103]
    ds_read_b64_tr_b16 v[164:165], v224 offset:32768
    v_mfma_f32_16x16x32_bf16 v[108:111], v[212:215], v[156:159], v[108:111]
    ds_read_b64_tr_b16 v[166:167], v224 offset:33280
    v_mfma_f32_16x16x32_bf16 v[80:83], v[216:219], v[144:147], v[80:83]
    ds_read_b64_tr_b16 v[168:169], v181 offset:32768
    buffer_load_dwordx4 v184, s[8:11], s16 offen offset:2048 lds
    v_mfma_f32_16x16x32_bf16 v[88:91], v[216:219], v[148:151], v[88:91]
    ds_read_b64_tr_b16 v[170:171], v181 offset:33280
    v_mfma_f32_16x16x32_bf16 v[112:115], v[216:219], v[152:155], v[112:115]
    ds_read_b128 v[136:139], v176 offset:36864
    v_mfma_f32_16x16x32_bf16 v[120:123], v[216:219], v[156:159], v[120:123]
    buffer_load_dwordx4 v185, s[8:11], s16 offen offset:3072 lds
    v_mfma_f32_16x16x32_bf16 v[84:87], v[220:223], v[144:147], v[84:87]
    ds_read_b128 v[140:143], v177 offset:36864
    v_mfma_f32_16x16x32_bf16 v[92:95], v[220:223], v[148:151], v[92:95]
    ds_read_b64_tr_b16 v[172:173], v225 offset:32768
    v_mfma_f32_16x16x32_bf16 v[116:119], v[220:223], v[152:155], v[116:119]
    ds_read_b64_tr_b16 v[174:175], v225 offset:33280
    v_mfma_f32_16x16x32_bf16 v[124:127], v[220:223], v[156:159], v[124:127]
    s_add_u32 s16, s16, 128
    s_waitcnt lgkmcnt(0)
    v_mfma_f32_16x16x32_bf16 v[0:3], v[160:163], v[128:131], v[0:3]
    s_add_u32 m0, s20, 0
    v_mfma_f32_16x16x32_bf16 v[8:11], v[160:163], v[132:135], v[8:11]
    ds_read_b64_tr_b16 v[208:209], v180 offset:36864
    v_mfma_f32_16x16x32_bf16 v[32:35], v[160:163], v[136:139], v[32:35]
    buffer_load_dwordx4 v186, s[12:15], s17 offen offset:0 lds
    v_mfma_f32_16x16x32_bf16 v[40:43], v[160:163], v[140:143], v[40:43]
    ds_read_b64_tr_b16 v[210:211], v180 offset:37376
    v_mfma_f32_16x16x32_bf16 v[4:7], v[164:167], v[128:131], v[4:7]
    ds_read_b128 v[144:147], v176 offset:40960
    v_mfma_f32_16x16x32_bf16 v[12:15], v[164:167], v[132:135], v[12:15]
    buffer_load_dwordx4 v187, s[12:15], s17 offen offset:1024 lds
    v_mfma_f32_16x16x32_bf16 v[36:39], v[164:167], v[136:139], v[36:39]
    ds_read_b128 v[148:151], v177 offset:40960
    v_mfma_f32_16x16x32_bf16 v[44:47], v[164:167], v[140:143], v[44:47]
    v_mfma_f32_16x16x32_bf16 v[16:19], v[168:171], v[128:131], v[16:19]
    buffer_load_dwordx4 v188, s[12:15], s17 offen offset:2048 lds
    v_mfma_f32_16x16x32_bf16 v[24:27], v[168:171], v[132:135], v[24:27]
    ds_read_b64_tr_b16 v[212:213], v224 offset:36864
    v_mfma_f32_16x16x32_bf16 v[48:51], v[168:171], v[136:139], v[48:51]
    ds_read_b64_tr_b16 v[214:215], v224 offset:37376
    v_mfma_f32_16x16x32_bf16 v[56:59], v[168:171], v[140:143], v[56:59]
    buffer_load_dwordx4 v189, s[12:15], s17 offen offset:3072 lds
    v_mfma_f32_16x16x32_bf16 v[20:23], v[172:175], v[128:131], v[20:23]
    ds_read_b128 v[152:155], v176 offset:45056
    v_mfma_f32_16x16x32_bf16 v[28:31], v[172:175], v[132:135], v[28:31]
    ds_read_b128 v[156:159], v177 offset:45056
    v_mfma_f32_16x16x32_bf16 v[52:55], v[172:175], v[136:139], v[52:55]
    s_add_u32 s17, s17, s18
    v_mfma_f32_16x16x32_bf16 v[60:63], v[172:175], v[140:143], v[60:63]
    s_waitcnt lgkmcnt(0)
    v_mfma_f32_16x16x32_bf16 v[64:67], v[160:163], v[144:147], v[64:67]
    ds_read_b64_tr_b16 v[216:217], v181 offset:36864
    v_mfma_f32_16x16x32_bf16 v[72:75], v[160:163], v[148:151], v[72:75]
    ds_read_b64_tr_b16 v[218:219], v181 offset:37376
    v_mfma_f32_16x16x32_bf16 v[96:99], v[160:163], v[152:155], v[96:99]
    v_mfma_f32_16x16x32_bf16 v[104:107], v[160:163], v[156:159], v[104:107]
    ds_read_b128 v[128:131], v178 offset:32768
    v_mfma_f32_16x16x32_bf16 v[68:71], v[164:167], v[144:147], v[68:71]
    v_mfma_f32_16x16x32_bf16 v[76:79], v[164:167], v[148:151], v[76:79]
    ds_read_b128 v[132:135], v179 offset:32768
    v_mfma_f32_16x16x32_bf16 v[100:103], v[164:167], v[152:155], v[100:103]
    v_mfma_f32_16x16x32_bf16 v[108:111], v[164:167], v[156:159], v[108:111]
    ds_read_b64_tr_b16 v[220:221], v225 offset:36864
    v_mfma_f32_16x16x32_bf16 v[80:83], v[168:171], v[144:147], v[80:83]
    ds_read_b64_tr_b16 v[222:223], v225 offset:37376
    v_mfma_f32_16x16x32_bf16 v[88:91], v[168:171], v[148:151], v[88:91]
    v_mfma_f32_16x16x32_bf16 v[112:115], v[168:171], v[152:155], v[112:115]
    ds_read_b128 v[136:139], v178 offset:36864
    v_mfma_f32_16x16x32_bf16 v[120:123], v[168:171], v[156:159], v[120:123]
    v_mfma_f32_16x16x32_bf16 v[84:87], v[172:175], v[144:147], v[84:87]
    ds_read_b128 v[140:143], v179 offset:36864
    v_mfma_f32_16x16x32_bf16 v[92:95], v[172:175], v[148:151], v[92:95]
    v_mfma_f32_16x16x32_bf16 v[116:119], v[172:175], v[152:155], v[116:119]
    buffer_load_dword v197, v199, s[12:15], s17 offen
    v_mfma_f32_16x16x32_bf16 v[124:127], v[172:175], v[156:159], v[124:127]
    s_waitcnt lgkmcnt(0)
    v_mfma_f32_16x16x32_bf16 v[0:3], v[208:211], v[128:131], v[0:3]
    ds_read_b128 v[144:147], v178 offset:40960
    v_mfma_f32_16x16x32_bf16 v[8:11], v[208:211], v[132:135], v[8:11]
    v_mfma_f32_16x16x32_bf16 v[32:35], v[208:211], v[136:139], v[32:35]
    v_mfma_f32_16x16x32_bf16 v[40:43], v[208:211], v[140:143], v[40:43]
    ds_read_b128 v[148:151], v179 offset:40960
    v_mfma_f32_16x16x32_bf16 v[4:7], v[212:215], v[128:131], v[4:7]
    v_mfma_f32_16x16x32_bf16 v[12:15], v[212:215], v[132:135], v[12:15]
    v_mfma_f32_16x16x32_bf16 v[36:39], v[212:215], v[136:139], v[36:39]
    ds_read_b128 v[152:155], v178 offset:45056
    v_mfma_f32_16x16x32_bf16 v[44:47], v[212:215], v[140:143], v[44:47]
    v_mfma_f32_16x16x32_bf16 v[16:19], v[216:219], v[128:131], v[16:19]
    v_mfma_f32_16x16x32_bf16 v[24:27], v[216:219], v[132:135], v[24:27]
    ds_read_b128 v[156:159], v179 offset:45056
    v_mfma_f32_16x16x32_bf16 v[48:51], v[216:219], v[136:139], v[48:51]
    v_mfma_f32_16x16x32_bf16 v[56:59], v[216:219], v[140:143], v[56:59]
    v_mfma_f32_16x16x32_bf16 v[20:23], v[220:223], v[128:131], v[20:23]
    buffer_load_dword v253, v250, s[48:51], s61 offen offset:64
    v_mfma_f32_16x16x32_bf16 v[28:31], v[220:223], v[132:135], v[28:31]
    v_mfma_f32_16x16x32_bf16 v[52:55], v[220:223], v[136:139], v[52:55]
    v_mfma_f32_16x16x32_bf16 v[60:63], v[220:223], v[140:143], v[60:63]
    s_waitcnt vmcnt(2) lgkmcnt(0)
    s_barrier
    v_mfma_f32_16x16x32_bf16 v[64:67], v[208:211], v[144:147], v[64:67]
    s_add_u32 m0, s19, 32768
    ds_read_b64_tr_b16 v[160:161], v180 offset:0
    v_mfma_f32_16x16x32_bf16 v[72:75], v[208:211], v[148:151], v[72:75]
    ds_read_b64_tr_b16 v[162:163], v180 offset:512
    v_mfma_f32_16x16x32_bf16 v[96:99], v[208:211], v[152:155], v[96:99]
    buffer_load_dwordx4 v182, s[8:11], s16 offen offset:0 lds
    v_mfma_f32_16x16x32_bf16 v[104:107], v[208:211], v[156:159], v[104:107]
    ds_read_b128 v[128:131], v176 offset:0
    v_mfma_f32_16x16x32_bf16 v[68:71], v[212:215], v[144:147], v[68:71]
    ds_read_b128 v[132:135], v177 offset:0
    v_mfma_f32_16x16x32_bf16 v[76:79], v[212:215], v[148:151], v[76:79]
    buffer_load_dwordx4 v183, s[8:11], s16 offen offset:1024 lds
    v_mfma_f32_16x16x32_bf16 v[100:103], v[212:215], v[152:155], v[100:103]
    ds_read_b64_tr_b16 v[164:165], v224 offset:0
    v_mfma_f32_16x16x32_bf16 v[108:111], v[212:215], v[156:159], v[108:111]
    ds_read_b64_tr_b16 v[166:167], v224 offset:512
    v_mfma_f32_16x16x32_bf16 v[80:83], v[216:219], v[144:147], v[80:83]
    ds_read_b64_tr_b16 v[168:169], v181 offset:0
    buffer_load_dwordx4 v184, s[8:11], s16 offen offset:2048 lds
    v_mfma_f32_16x16x32_bf16 v[88:91], v[216:219], v[148:151], v[88:91]
    ds_read_b64_tr_b16 v[170:171], v181 offset:512
    v_mfma_f32_16x16x32_bf16 v[112:115], v[216:219], v[152:155], v[112:115]
    ds_read_b128 v[136:139], v176 offset:4096
    v_mfma_f32_16x16x32_bf16 v[120:123], v[216:219], v[156:159], v[120:123]
    buffer_load_dwordx4 v185, s[8:11], s16 offen offset:3072 lds
    v_mfma_f32_16x16x32_bf16 v[84:87], v[220:223], v[144:147], v[84:87]
    ds_read_b128 v[140:143], v177 offset:4096
    v_mfma_f32_16x16x32_bf16 v[92:95], v[220:223], v[148:151], v[92:95]
    ds_read_b64_tr_b16 v[172:173], v225 offset:0
    v_mfma_f32_16x16x32_bf16 v[116:119], v[220:223], v[152:155], v[116:119]
    ds_read_b64_tr_b16 v[174:175], v225 offset:512
    v_mfma_f32_16x16x32_bf16 v[124:127], v[220:223], v[156:159], v[124:127]
    s_add_u32 s16, s16, 128
    s_sub_u32 s69, s69, 1
    s_cmp_lg_u32 s69, 0
    s_cbranch_scc1 K1_G0
    v_and_b32 v191, 15, v190
    v_lshlrev_b32 v191, 4, v191
    v_bfe_u32 v192, v190, 4, 1
    v_lshl_or_b32 v191, v192, 9, v191
    v_lshrrev_b32 v192, 5, v190
    v_lshl_or_b32 v191, v192, 10, v191
    s_lshr_b32 s3, s21, 2
    s_lshl_b32 s4, s23, 1
    s_add_u32 s3, s3, s4
    s_lshl_b32 s3, s3, 15
    s_and_b32 s4, s21, 1
    s_lshl_b32 s4, s4, 12
    s_add_u32 s3, s3, s4
    s_waitcnt lgkmcnt(0)
    s_nop 4
    v_cvt_pk_bf16_f32 v128, v0, v1
    v_cvt_pk_bf16_f32 v129, v2, v3
    v_cvt_pk_bf16_f32 v130, v4, v5
    v_cvt_pk_bf16_f32 v131, v6, v7
    buffer_store_dwordx4 v[128:131], v191, s[44:47], s3 offen offset:0 sc1
    v_cvt_pk_bf16_f32 v132, v8, v9
    v_cvt_pk_bf16_f32 v133, v10, v11
    v_cvt_pk_bf16_f32 v134, v12, v13
    v_cvt_pk_bf16_f32 v135, v14, v15
    buffer_store_dwordx4 v[132:135], v191, s[44:47], s3 offen offset:256 sc1
    v_cvt_pk_bf16_f32 v136, v16, v17
    v_cvt_pk_bf16_f32 v137, v18, v19
    v_cvt_pk_bf16_f32 v138, v20, v21
    v_cvt_pk_bf16_f32 v139, v22, v23
    buffer_store_dwordx4 v[136:139], v191, s[44:47], s3 offen offset:2048 sc1
    v_cvt_pk_bf16_f32 v140, v24, v25
    v_cvt_pk_bf16_f32 v141, v26, v27
    v_cvt_pk_bf16_f32 v142, v28, v29
    v_cvt_pk_bf16_f32 v143, v30, v31
    buffer_store_dwordx4 v[140:143], v191, s[44:47], s3 offen offset:2304 sc1
    s_add_u32 s3, s3, 8192
    v_cvt_pk_bf16_f32 v144, v32, v33
    v_cvt_pk_bf16_f32 v145, v34, v35
    v_cvt_pk_bf16_f32 v146, v36, v37
    v_cvt_pk_bf16_f32 v147, v38, v39
    buffer_store_dwordx4 v[144:147], v191, s[44:47], s3 offen offset:0 sc1
    v_cvt_pk_bf16_f32 v148, v40, v41
    v_cvt_pk_bf16_f32 v149, v42, v43
    v_cvt_pk_bf16_f32 v150, v44, v45
    v_cvt_pk_bf16_f32 v151, v46, v47
    buffer_store_dwordx4 v[148:151], v191, s[44:47], s3 offen offset:256 sc1
    v_cvt_pk_bf16_f32 v152, v48, v49
    v_cvt_pk_bf16_f32 v153, v50, v51
    v_cvt_pk_bf16_f32 v154, v52, v53
    v_cvt_pk_bf16_f32 v155, v54, v55
    buffer_store_dwordx4 v[152:155], v191, s[44:47], s3 offen offset:2048 sc1
    v_cvt_pk_bf16_f32 v156, v56, v57
    v_cvt_pk_bf16_f32 v157, v58, v59
    v_cvt_pk_bf16_f32 v158, v60, v61
    v_cvt_pk_bf16_f32 v159, v62, v63
    buffer_store_dwordx4 v[156:159], v191, s[44:47], s3 offen offset:2304 sc1
    s_add_u32 s3, s3, 8192
    v_cvt_pk_bf16_f32 v128, v64, v65
    v_cvt_pk_bf16_f32 v129, v66, v67
    v_cvt_pk_bf16_f32 v130, v68, v69
    v_cvt_pk_bf16_f32 v131, v70, v71
    buffer_store_dwordx4 v[128:131], v191, s[44:47], s3 offen offset:0 sc1
    v_cvt_pk_bf16_f32 v132, v72, v73
    v_cvt_pk_bf16_f32 v133, v74, v75
    v_cvt_pk_bf16_f32 v134, v76, v77
    v_cvt_pk_bf16_f32 v135, v78, v79
    buffer_store_dwordx4 v[132:135], v191, s[44:47], s3 offen offset:256 sc1
    v_cvt_pk_bf16_f32 v136, v80, v81
    v_cvt_pk_bf16_f32 v137, v82, v83
    v_cvt_pk_bf16_f32 v138, v84, v85
    v_cvt_pk_bf16_f32 v139, v86, v87
    buffer_store_dwordx4 v[136:139], v191, s[44:47], s3 offen offset:2048 sc1
    v_cvt_pk_bf16_f32 v140, v88, v89
    v_cvt_pk_bf16_f32 v141, v90, v91
    v_cvt_pk_bf16_f32 v142, v92, v93
    v_cvt_pk_bf16_f32 v143, v94, v95
    buffer_store_dwordx4 v[140:143], v191, s[44:47], s3 offen offset:2304 sc1
    s_add_u32 s3, s3, 8192
    v_cvt_pk_bf16_f32 v144, v96, v97
    v_cvt_pk_bf16_f32 v145, v98, v99
    v_cvt_pk_bf16_f32 v146, v100, v101
    v_cvt_pk_bf16_f32 v147, v102, v103
    buffer_store_dwordx4 v[144:147], v191, s[44:47], s3 offen offset:0 sc1
    v_cvt_pk_bf16_f32 v148, v104, v105
    v_cvt_pk_bf16_f32 v149, v106, v107
    v_cvt_pk_bf16_f32 v150, v108, v109
    v_cvt_pk_bf16_f32 v151, v110, v111
    buffer_store_dwordx4 v[148:151], v191, s[44:47], s3 offen offset:256 sc1
    v_cvt_pk_bf16_f32 v152, v112, v113
    v_cvt_pk_bf16_f32 v153, v114, v115
    v_cvt_pk_bf16_f32 v154, v116, v117
    v_cvt_pk_bf16_f32 v155, v118, v119
    buffer_store_dwordx4 v[152:155], v191, s[44:47], s3 offen offset:2048 sc1
    v_cvt_pk_bf16_f32 v156, v120, v121
    v_cvt_pk_bf16_f32 v157, v122, v123
    v_cvt_pk_bf16_f32 v158, v124, v125
    v_cvt_pk_bf16_f32 v159, v126, v127
    buffer_store_dwordx4 v[156:159], v191, s[44:47], s3 offen offset:2304 sc1
    s_add_u32 s3, s3, 8192
    s_endpgm
K1_V:
    v_xor_b32 v177, 544, v176
    v_xor_b32 v178, 64, v176
    v_xor_b32 v179, 608, v176
    v_xor_b32 v224, 8, v180
    v_xor_b32 v225, 8, v181
    ds_read_b64_tr_b16 v[160:161], v180 offset:0
    ds_read_b64_tr_b16 v[162:163], v180 offset:512
    ds_read_b128 v[128:131], v176 offset:0
    ds_read_b128 v[132:135], v177 offset:0
    ds_read_b64_tr_b16 v[164:165], v224 offset:0
    ds_read_b64_tr_b16 v[166:167], v224 offset:512
    ds_read_b64_tr_b16 v[168:169], v181 offset:0
    ds_read_b64_tr_b16 v[170:171], v181 offset:512
    ds_read_b128 v[136:139], v176 offset:4096
    ds_read_b128 v[140:143], v177 offset:4096
    ds_read_b64_tr_b16 v[172:173], v225 offset:0
    ds_read_b64_tr_b16 v[174:175], v225 offset:512
    buffer_load_dword v197, v198, s[8:11], s16 offen
    buffer_load_dword v197, v199, s[12:15], s17 offen
    s_mov_b32 s69, 4
K1_G1:
    s_cmp_eq_u32 s69, 1
    s_cselect_b32 s10, 0, s10
    s_cmp_eq_u32 s69, s62
    s_cselect_b32 s50, s60, 0
    s_waitcnt lgkmcnt(0)
    v_mfma_f32_16x16x32_bf16 v[0:3], v[128:131], v[160:163], v[0:3]
    s_add_u32 m0, s20, 32768
    v_mfma_f32_16x16x32_bf16 v[4:7], v[132:135], v[160:163], v[4:7]
    ds_read_b64_tr_b16 v[208:209], v180 offset:4096
    v_mfma_f32_16x16x32_bf16 v[32:35], v[136:139], v[160:163], v[32:35]
    buffer_load_dwordx4 v186, s[12:15], s17 offen offset:0 lds
    v_mfma_f32_16x16x32_bf16 v[36:39], v[140:143], v[160:163], v[36:39]
    ds_read_b64_tr_b16 v[210:211], v180 offset:4608
    v_mfma_f32_16x16x32_bf16 v[8:11], v[128:131], v[164:167], v[8:11]
    ds_read_b128 v[144:147], v176 offset:8192
    v_mfma_f32_16x16x32_bf16 v[12:15], v[132:135], v[164:167], v[12:15]
    buffer_load_dwordx4 v187, s[12:15], s17 offen offset:1024 lds
    v_mfma_f32_16x16x32_bf16 v[40:43], v[136:139], v[164:167], v[40:43]
    ds_read_b128 v[148:151], v177 offset:8192
    v_mfma_f32_16x16x32_bf16 v[44:47], v[140:143], v[164:167], v[44:47]
    buffer_load_dwordx4 v188, s[12:15], s17 offen offset:2048 lds
    v_mfma_f32_16x16x32_bf16 v[16:19], v[128:131], v[168:171], v[16:19]
    ds_read_b64_tr_b16 v[212:213], v224 offset:4096
    v_mfma_f32_16x16x32_bf16 v[20:23], v[132:135], v[168:171], v[20:23]
    ds_read_b64_tr_b16 v[214:215], v224 offset:4608
    v_mfma_f32_16x16x32_bf16 v[48:51], v[136:139], v[168:171], v[48:51]
    buffer_load_dwordx4 v189, s[12:15], s17 offen offset:3072 lds
    v_mfma_f32_16x16x32_bf16 v[52:55], v[140:143], v[168:171], v[52:55]
    ds_read_b128 v[152:155], v176 offset:12288
    v_mfma_f32_16x16x32_bf16 v[24:27], v[128:131], v[172:175], v[24:27]
    ds_read_b128 v[156:159], v177 offset:12288
    v_mfma_f32_16x16x32_bf16 v[28:31], v[132:135], v[172:175], v[28:31]
    s_add_u32 s17, s17, s18
    v_mfma_f32_16x16x32_bf16 v[56:59], v[136:139], v[172:175], v[56:59]
    s_cmp_eq_u32 s69, 1
    v_mfma_f32_16x16x32_bf16 v[60:63], v[140:143], v[172:175], v[60:63]
    s_cselect_b32 s14, 0, s14
    s_waitcnt lgkmcnt(0)
    v_mfma_f32_16x16x32_bf16 v[64:67], v[144:147], v[160:163], v[64:67]
    ds_read_b64_tr_b16 v[216:217], v181 offset:4096
    v_mfma_f32_16x16x32_bf16 v[68:71], v[148:151], v[160:163], v[68:71]
    ds_read_b64_tr_b16 v[218:219], v181 offset:4608
    v_mfma_f32_16x16x32_bf16 v[96:99], v[152:155], v[160:163], v[96:99]
    v_mfma_f32_16x16x32_bf16 v[100:103], v[156:159], v[160:163], v[100:103]
    ds_read_b128 v[128:131], v178 offset:0
    v_mfma_f32_16x16x32_bf16 v[72:75], v[144:147], v[164:167], v[72:75]
    v_mfma_f32_16x16x32_bf16 v[76:79], v[148:151], v[164:167], v[76:79]
    ds_read_b128 v[132:135], v179 offset:0
    v_mfma_f32_16x16x32_bf16 v[104:107], v[152:155], v[164:167], v[104:107]
    v_mfma_f32_16x16x32_bf16 v[108:111], v[156:159], v[164:167], v[108:111]
    ds_read_b64_tr_b16 v[220:221], v225 offset:4096
    v_mfma_f32_16x16x32_bf16 v[80:83], v[144:147], v[168:171], v[80:83]
    ds_read_b64_tr_b16 v[222:223], v225 offset:4608
    v_mfma_f32_16x16x32_bf16 v[84:87], v[148:151], v[168:171], v[84:87]
    v_mfma_f32_16x16x32_bf16 v[112:115], v[152:155], v[168:171], v[112:115]
    ds_read_b128 v[136:139], v178 offset:4096
    v_mfma_f32_16x16x32_bf16 v[116:119], v[156:159], v[168:171], v[116:119]
    v_mfma_f32_16x16x32_bf16 v[88:91], v[144:147], v[172:175], v[88:91]
    ds_read_b128 v[140:143], v179 offset:4096
    v_mfma_f32_16x16x32_bf16 v[92:95], v[148:151], v[172:175], v[92:95]
    v_mfma_f32_16x16x32_bf16 v[120:123], v[152:155], v[172:175], v[120:123]
    buffer_load_dword v197, v198, s[8:11], s16 offen offset:256
    v_mfma_f32_16x16x32_bf16 v[124:127], v[156:159], v[172:175], v[124:127]
    s_waitcnt lgkmcnt(0)
    v_mfma_f32_16x16x32_bf16 v[0:3], v[128:131], v[208:211], v[0:3]
    ds_read_b128 v[144:147], v178 offset:8192
    v_mfma_f32_16x16x32_bf16 v[4:7], v[132:135], v[208:211], v[4:7]
    v_mfma_f32_16x16x32_bf16 v[32:35], v[136:139], v[208:211], v[32:35]
    v_mfma_f32_16x16x32_bf16 v[36:39], v[140:143], v[208:211], v[36:39]
    ds_read_b128 v[148:151], v179 offset:8192
    v_mfma_f32_16x16x32_bf16 v[8:11], v[128:131], v[212:215], v[8:11]
    v_mfma_f32_16x16x32_bf16 v[12:15], v[132:135], v[212:215], v[12:15]
    v_mfma_f32_16x16x32_bf16 v[40:43], v[136:139], v[212:215], v[40:43]
    ds_read_b128 v[152:155], v178 offset:12288
    v_mfma_f32_16x16x32_bf16 v[44:47], v[140:143], v[212:215], v[44:47]
    v_mfma_f32_16x16x32_bf16 v[16:19], v[128:131], v[216:219], v[16:19]
    v_mfma_f32_16x16x32_bf16 v[20:23], v[132:135], v[216:219], v[20:23]
    ds_read_b128 v[156:159], v179 offset:12288
    v_mfma_f32_16x16x32_bf16 v[48:51], v[136:139], v[216:219], v[48:51]
    v_mfma_f32_16x16x32_bf16 v[52:55], v[140:143], v[216:219], v[52:55]
    v_mfma_f32_16x16x32_bf16 v[24:27], v[128:131], v[220:223], v[24:27]
    buffer_load_dword v253, v250, s[48:51], s61 offen offset:0
    v_mfma_f32_16x16x32_bf16 v[28:31], v[132:135], v[220:223], v[28:31]
    v_mfma_f32_16x16x32_bf16 v[56:59], v[136:139], v[220:223], v[56:59]
    v_mfma_f32_16x16x32_bf16 v[60:63], v[140:143], v[220:223], v[60:63]
    s_waitcnt vmcnt(2) lgkmcnt(0)
    s_barrier
    v_mfma_f32_16x16x32_bf16 v[64:67], v[144:147], v[208:211], v[64:67]
    s_add_u32 m0, s19, 0
    ds_read_b64_tr_b16 v[160:161], v180 offset:32768
    v_mfma_f32_16x16x32_bf16 v[68:71], v[148:151], v[208:211], v[68:71]
    ds_read_b64_tr_b16 v[162:163], v180 offset:33280
    v_mfma_f32_16x16x32_bf16 v[96:99], v[152:155], v[208:211], v[96:99]
    buffer_load_dwordx4 v182, s[8:11], s16 offen offset:0 lds
    v_mfma_f32_16x16x32_bf16 v[100:103], v[156:159], v[208:211], v[100:103]
    ds_read_b128 v[128:131], v176 offset:32768
    v_mfma_f32_16x16x32_bf16 v[72:75], v[144:147], v[212:215], v[72:75]
    ds_read_b128 v[132:135], v177 offset:32768
    v_mfma_f32_16x16x32_bf16 v[76:79], v[148:151], v[212:215], v[76:79]
    buffer_load_dwordx4 v183, s[8:11], s16 offen offset:1024 lds
    v_mfma_f32_16x16x32_bf16 v[104:107], v[152:155], v[212:215], v[104:107]
    ds_read_b64_tr_b16 v[164:165], v224 offset:32768
    v_mfma_f32_16x16x32_bf16 v[108:111], v[156:159], v[212:215], v[108:111]
    ds_read_b64_tr_b16 v[166:167], v224 offset:33280
    v_mfma_f32_16x16x32_bf16 v[80:83], v[144:147], v[216:219], v[80:83]
    ds_read_b64_tr_b16 v[168:169], v181 offset:32768
    buffer_load_dwordx4 v184, s[8:11], s16 offen offset:2048 lds
    v_mfma_f32_16x16x32_bf16 v[84:87], v[148:151], v[216:219], v[84:87]
    ds_read_b64_tr_b16 v[170:171], v181 offset:33280
    v_mfma_f32_16x16x32_bf16 v[112:115], v[152:155], v[216:219], v[112:115]
    ds_read_b128 v[136:139], v176 offset:36864
    v_mfma_f32_16x16x32_bf16 v[116:119], v[156:159], v[216:219], v[116:119]
    buffer_load_dwordx4 v185, s[8:11], s16 offen offset:3072 lds
    v_mfma_f32_16x16x32_bf16 v[88:91], v[144:147], v[220:223], v[88:91]
    ds_read_b128 v[140:143], v177 offset:36864
    v_mfma_f32_16x16x32_bf16 v[92:95], v[148:151], v[220:223], v[92:95]
    ds_read_b64_tr_b16 v[172:173], v225 offset:32768
    v_mfma_f32_16x16x32_bf16 v[120:123], v[152:155], v[220:223], v[120:123]
    ds_read_b64_tr_b16 v[174:175], v225 offset:33280
    v_mfma_f32_16x16x32_bf16 v[124:127], v[156:159], v[220:223], v[124:127]
    s_add_u32 s16, s16, 128
    s_waitcnt lgkmcnt(0)
    v_mfma_f32_16x16x32_bf16 v[0:3], v[128:131], v[160:163], v[0:3]
    s_add_u32 m0, s20, 0
    v_mfma_f32_16x16x32_bf16 v[4:7], v[132:135], v[160:163], v[4:7]
    ds_read_b64_tr_b16 v[208:209], v180 offset:36864
    v_mfma_f32_16x16x32_bf16 v[32:35], v[136:139], v[160:163], v[32:35]
    buffer_load_dwordx4 v186, s[12:15], s17 offen offset:0 lds
    v_mfma_f32_16x16x32_bf16 v[36:39], v[140:143], v[160:163], v[36:39]
    ds_read_b64_tr_b16 v[210:211], v180 offset:37376
    v_mfma_f32_16x16x32_bf16 v[8:11], v[128:131], v[164:167], v[8:11]
    ds_read_b128 v[144:147], v176 offset:40960
    v_mfma_f32_16x16x32_bf16 v[12:15], v[132:135], v[164:167], v[12:15]
    buffer_load_dwordx4 v187, s[12:15], s17 offen offset:1024 lds
    v_mfma_f32_16x16x32_bf16 v[40:43], v[136:139], v[164:167], v[40:43]
    ds_read_b128 v[148:151], v177 offset:40960
    v_mfma_f32_16x16x32_bf16 v[44:47], v[140:143], v[164:167], v[44:47]
    v_mfma_f32_16x16x32_bf16 v[16:19], v[128:131], v[168:171], v[16:19]
    buffer_load_dwordx4 v188, s[12:15], s17 offen offset:2048 lds
    v_mfma_f32_16x16x32_bf16 v[20:23], v[132:135], v[168:171], v[20:23]
    ds_read_b64_tr_b16 v[212:213], v224 offset:36864
    v_mfma_f32_16x16x32_bf16 v[48:51], v[136:139], v[168:171], v[48:51]
    ds_read_b64_tr_b16 v[214:215], v224 offset:37376
    v_mfma_f32_16x16x32_bf16 v[52:55], v[140:143], v[168:171], v[52:55]
    buffer_load_dwordx4 v189, s[12:15], s17 offen offset:3072 lds
    v_mfma_f32_16x16x32_bf16 v[24:27], v[128:131], v[172:175], v[24:27]
    ds_read_b128 v[152:155], v176 offset:45056
    v_mfma_f32_16x16x32_bf16 v[28:31], v[132:135], v[172:175], v[28:31]
    ds_read_b128 v[156:159], v177 offset:45056
    v_mfma_f32_16x16x32_bf16 v[56:59], v[136:139], v[172:175], v[56:59]
    s_add_u32 s17, s17, s18
    v_mfma_f32_16x16x32_bf16 v[60:63], v[140:143], v[172:175], v[60:63]
    s_waitcnt lgkmcnt(0)
    v_mfma_f32_16x16x32_bf16 v[64:67], v[144:147], v[160:163], v[64:67]
    ds_read_b64_tr_b16 v[216:217], v181 offset:36864
    v_mfma_f32_16x16x32_bf16 v[68:71], v[148:151], v[160:163], v[68:71]
    ds_read_b64_tr_b16 v[218:219], v181 offset:37376
    v_mfma_f32_16x16x32_bf16 v[96:99], v[152:155], v[160:163], v[96:99]
    v_mfma_f32_16x16x32_bf16 v[100:103], v[156:159], v[160:163], v[100:103]
    ds_read_b128 v[128:131], v178 offset:32768
    v_mfma_f32_16x16x32_bf16 v[72:75], v[144:147], v[164:167], v[72:75]
    v_mfma_f32_16x16x32_bf16 v[76:79], v[148:151], v[164:167], v[76:79]
    ds_read_b128 v[132:135], v179 offset:32768
    v_mfma_f32_16x16x32_bf16 v[104:107], v[152:155], v[164:167], v[104:107]
    v_mfma_f32_16x16x32_bf16 v[108:111], v[156:159], v[164:167], v[108:111]
    ds_read_b64_tr_b16 v[220:221], v225 offset:36864
    v_mfma_f32_16x16x32_bf16 v[80:83], v[144:147], v[168:171], v[80:83]
    ds_read_b64_tr_b16 v[222:223], v225 offset:37376
    v_mfma_f32_16x16x32_bf16 v[84:87], v[148:151], v[168:171], v[84:87]
    v_mfma_f32_16x16x32_bf16 v[112:115], v[152:155], v[168:171], v[112:115]
    ds_read_b128 v[136:139], v178 offset:36864
    v_mfma_f32_16x16x32_bf16 v[116:119], v[156:159], v[168:171], v[116:119]
    v_mfma_f32_16x16x32_bf16 v[88:91], v[144:147], v[172:175], v[88:91]
    ds_read_b128 v[140:143], v179 offset:36864
    v_mfma_f32_16x16x32_bf16 v[92:95], v[148:151], v[172:175], v[92:95]
    v_mfma_f32_16x16x32_bf16 v[120:123], v[152:155], v[172:175], v[120:123]
    buffer_load_dword v197, v199, s[12:15], s17 offen
    v_mfma_f32_16x16x32_bf16 v[124:127], v[156:159], v[172:175], v[124:127]
    s_waitcnt lgkmcnt(0)
    v_mfma_f32_16x16x32_bf16 v[0:3], v[128:131], v[208:211], v[0:3]
    ds_read_b128 v[144:147], v178 offset:40960
    v_mfma_f32_16x16x32_bf16 v[4:7], v[132:135], v[208:211], v[4:7]
    v_mfma_f32_16x16x32_bf16 v[32:35], v[136:139], v[208:211], v[32:35]
    v_mfma_f32_16x16x32_bf16 v[36:39], v[140:143], v[208:211], v[36:39]
    ds_read_b128 v[148:151], v179 offset:40960
    v_mfma_f32_16x16x32_bf16 v[8:11], v[128:131], v[212:215], v[8:11]
    v_mfma_f32_16x16x32_bf16 v[12:15], v[132:135], v[212:215], v[12:15]
    v_mfma_f32_16x16x32_bf16 v[40:43], v[136:139], v[212:215], v[40:43]
    ds_read_b128 v[152:155], v178 offset:45056
    v_mfma_f32_16x16x32_bf16 v[44:47], v[140:143], v[212:215], v[44:47]
    v_mfma_f32_16x16x32_bf16 v[16:19], v[128:131], v[216:219], v[16:19]
    v_mfma_f32_16x16x32_bf16 v[20:23], v[132:135], v[216:219], v[20:23]
    ds_read_b128 v[156:159], v179 offset:45056
    v_mfma_f32_16x16x32_bf16 v[48:51], v[136:139], v[216:219], v[48:51]
    v_mfma_f32_16x16x32_bf16 v[52:55], v[140:143], v[216:219], v[52:55]
    v_mfma_f32_16x16x32_bf16 v[24:27], v[128:131], v[220:223], v[24:27]
    buffer_load_dword v253, v250, s[48:51], s61 offen offset:64
    v_mfma_f32_16x16x32_bf16 v[28:31], v[132:135], v[220:223], v[28:31]
    v_mfma_f32_16x16x32_bf16 v[56:59], v[136:139], v[220:223], v[56:59]
    v_mfma_f32_16x16x32_bf16 v[60:63], v[140:143], v[220:223], v[60:63]
    s_waitcnt vmcnt(2) lgkmcnt(0)
    s_barrier
    v_mfma_f32_16x16x32_bf16 v[64:67], v[144:147], v[208:211], v[64:67]
    s_add_u32 m0, s19, 32768
    ds_read_b64_tr_b16 v[160:161], v180 offset:0
    v_mfma_f32_16x16x32_bf16 v[68:71], v[148:151], v[208:211], v[68:71]
    ds_read_b64_tr_b16 v[162:163], v180 offset:512
    v_mfma_f32_16x16x32_bf16 v[96:99], v[152:155], v[208:211], v[96:99]
    buffer_load_dwordx4 v182, s[8:11], s16 offen offset:0 lds
    v_mfma_f32_16x16x32_bf16 v[100:103], v[156:159], v[208:211], v[100:103]
    ds_read_b128 v[128:131], v176 offset:0
    v_mfma_f32_16x16x32_bf16 v[72:75], v[144:147], v[212:215], v[72:75]
    ds_read_b128 v[132:135], v177 offset:0
    v_mfma_f32_16x16x32_bf16 v[76:79], v[148:151], v[212:215], v[76:79]
    buffer_load_dwordx4 v183, s[8:11], s16 offen offset:1024 lds
    v_mfma_f32_16x16x32_bf16 v[104:107], v[152:155], v[212:215], v[104:107]
    ds_read_b64_tr_b16 v[164:165], v224 offset:0
    v_mfma_f32_16x16x32_bf16 v[108:111], v[156:159], v[212:215], v[108:111]
    ds_read_b64_tr_b16 v[166:167], v224 offset:512
    v_mfma_f32_16x16x32_bf16 v[80:83], v[144:147], v[216:219], v[80:83]
    ds_read_b64_tr_b16 v[168:169], v181 offset:0
    buffer_load_dwordx4 v184, s[8:11], s16 offen offset:2048 lds
    v_mfma_f32_16x16x32_bf16 v[84:87], v[148:151], v[216:219], v[84:87]
    ds_read_b64_tr_b16 v[170:171], v181 offset:512
    v_mfma_f32_16x16x32_bf16 v[112:115], v[152:155], v[216:219], v[112:115]
    ds_read_b128 v[136:139], v176 offset:4096
    v_mfma_f32_16x16x32_bf16 v[116:119], v[156:159], v[216:219], v[116:119]
    buffer_load_dwordx4 v185, s[8:11], s16 offen offset:3072 lds
    v_mfma_f32_16x16x32_bf16 v[88:91], v[144:147], v[220:223], v[88:91]
    ds_read_b128 v[140:143], v177 offset:4096
    v_mfma_f32_16x16x32_bf16 v[92:95], v[148:151], v[220:223], v[92:95]
    ds_read_b64_tr_b16 v[172:173], v225 offset:0
    v_mfma_f32_16x16x32_bf16 v[120:123], v[152:155], v[220:223], v[120:123]
    ds_read_b64_tr_b16 v[174:175], v225 offset:512
    v_mfma_f32_16x16x32_bf16 v[124:127], v[156:159], v[220:223], v[124:127]
    s_add_u32 s16, s16, 128
    s_sub_u32 s69, s69, 1
    s_cmp_lg_u32 s69, 0
    s_cbranch_scc1 K1_G1
    v_and_b32 v191, 15, v190
    v_lshlrev_b32 v191, 4, v191
    v_bfe_u32 v192, v190, 4, 1
    v_lshl_or_b32 v191, v192, 9, v191
    v_lshrrev_b32 v192, 5, v190
    v_lshl_or_b32 v191, v192, 8, v191
    v_bfe_u32 v192, v190, 2, 1
    v_lshl_or_b32 v191, v192, 10, v191
    v_xor_b32 v192, 1024, v191
    s_lshr_b32 s3, s21, 2
    s_lshl_b32 s4, s23, 1
    s_add_u32 s3, s3, s4
    s_lshl_b32 s3, s3, 15
    s_and_b32 s4, s21, 1
    s_lshl_b32 s4, s4, 12
    s_add_u32 s3, s3, s4
    s_waitcnt lgkmcnt(0)
    s_nop 4
    v_cvt_pk_bf16_f32 v128, v0, v1
    v_cvt_pk_bf16_f32 v129, v2, v3
    v_cvt_pk_bf16_f32 v130, v4, v5
    v_cvt_pk_bf16_f32 v131, v6, v7
    buffer_store_dwordx4 v[128:131], v191, s[44:47], s3 offen offset:0 sc1
    v_cvt_pk_bf16_f32 v132, v8, v9
    v_cvt_pk_bf16_f32 v133, v10, v11
    v_cvt_pk_bf16_f32 v134, v12, v13
    v_cvt_pk_bf16_f32 v135, v14, v15
    buffer_store_dwordx4 v[132:135], v192, s[44:47], s3 offen offset:0 sc1
    v_cvt_pk_bf16_f32 v136, v16, v17
    v_cvt_pk_bf16_f32 v137, v18, v19
    v_cvt_pk_bf16_f32 v138, v20, v21
    v_cvt_pk_bf16_f32 v139, v22, v23
    buffer_store_dwordx4 v[136:139], v191, s[44:47], s3 offen offset:2048 sc1
    v_cvt_pk_bf16_f32 v140, v24, v25
    v_cvt_pk_bf16_f32 v141, v26, v27
    v_cvt_pk_bf16_f32 v142, v28, v29
    v_cvt_pk_bf16_f32 v143, v30, v31
    buffer_store_dwordx4 v[140:143], v192, s[44:47], s3 offen offset:2048 sc1
    s_add_u32 s3, s3, 8192
    v_cvt_pk_bf16_f32 v144, v32, v33
    v_cvt_pk_bf16_f32 v145, v34, v35
    v_cvt_pk_bf16_f32 v146, v36, v37
    v_cvt_pk_bf16_f32 v147, v38, v39
    buffer_store_dwordx4 v[144:147], v191, s[44:47], s3 offen offset:0 sc1
    v_cvt_pk_bf16_f32 v148, v40, v41
    v_cvt_pk_bf16_f32 v149, v42, v43
    v_cvt_pk_bf16_f32 v150, v44, v45
    v_cvt_pk_bf16_f32 v151, v46, v47
    buffer_store_dwordx4 v[148:151], v192, s[44:47], s3 offen offset:0 sc1
    v_cvt_pk_bf16_f32 v152, v48, v49
    v_cvt_pk_bf16_f32 v153, v50, v51
    v_cvt_pk_bf16_f32 v154, v52, v53
    v_cvt_pk_bf16_f32 v155, v54, v55
    buffer_store_dwordx4 v[152:155], v191, s[44:47], s3 offen offset:2048 sc1
    v_cvt_pk_bf16_f32 v156, v56, v57
    v_cvt_pk_bf16_f32 v157, v58, v59
    v_cvt_pk_bf16_f32 v158, v60, v61
    v_cvt_pk_bf16_f32 v159, v62, v63
    buffer_store_dwordx4 v[156:159], v192, s[44:47], s3 offen offset:2048 sc1
    s_add_u32 s3, s3, 8192
    v_cvt_pk_bf16_f32 v128, v64, v65
    v_cvt_pk_bf16_f32 v129, v66, v67
    v_cvt_pk_bf16_f32 v130, v68, v69
    v_cvt_pk_bf16_f32 v131, v70, v71
    buffer_store_dwordx4 v[128:131], v191, s[44:47], s3 offen offset:0 sc1
    v_cvt_pk_bf16_f32 v132, v72, v73
    v_cvt_pk_bf16_f32 v133, v74, v75
    v_cvt_pk_bf16_f32 v134, v76, v77
    v_cvt_pk_bf16_f32 v135, v78, v79
    buffer_store_dwordx4 v[132:135], v192, s[44:47], s3 offen offset:0 sc1
    v_cvt_pk_bf16_f32 v136, v80, v81
    v_cvt_pk_bf16_f32 v137, v82, v83
    v_cvt_pk_bf16_f32 v138, v84, v85
    v_cvt_pk_bf16_f32 v139, v86, v87
    buffer_store_dwordx4 v[136:139], v191, s[44:47], s3 offen offset:2048 sc1
    v_cvt_pk_bf16_f32 v140, v88, v89
    v_cvt_pk_bf16_f32 v141, v90, v91
    v_cvt_pk_bf16_f32 v142, v92, v93
    v_cvt_pk_bf16_f32 v143, v94, v95
    buffer_store_dwordx4 v[140:143], v192, s[44:47], s3 offen offset:2048 sc1
    s_add_u32 s3, s3, 8192
    v_cvt_pk_bf16_f32 v144, v96, v97
    v_cvt_pk_bf16_f32 v145, v98, v99
    v_cvt_pk_bf16_f32 v146, v100, v101
    v_cvt_pk_bf16_f32 v147, v102, v103
    buffer_store_dwordx4 v[144:147], v191, s[44:47], s3 offen offset:0 sc1
    v_cvt_pk_bf16_f32 v148, v104, v105
    v_cvt_pk_bf16_f32 v149, v106, v107
    v_cvt_pk_bf16_f32 v150, v108, v109
    v_cvt_pk_bf16_f32 v151, v110, v111
    buffer_store_dwordx4 v[148:151], v192, s[44:47], s3 offen offset:0 sc1
    v_cvt_pk_bf16_f32 v152, v112, v113
    v_cvt_pk_bf16_f32 v153, v114, v115
    v_cvt_pk_bf16_f32 v154, v116, v117
    v_cvt_pk_bf16_f32 v155, v118, v119
    buffer_store_dwordx4 v[152:155], v191, s[44:47], s3 offen offset:2048 sc1
    v_cvt_pk_bf16_f32 v156, v120, v121
    v_cvt_pk_bf16_f32 v157, v122, v123
    v_cvt_pk_bf16_f32 v158, v124, v125
    v_cvt_pk_bf16_f32 v159, v126, v127
    buffer_store_dwordx4 v[156:159], v192, s[44:47], s3 offen offset:2048 sc1
    s_add_u32 s3, s3, 8192
    s_endpgm
K1_DONE:
    s_endpgm
.p2align 8
.globl k2_kernel
.type k2_kernel,@function
k2_kernel:
    s_cmp_ge_u32 s2, 256
    s_cbranch_scc1 K2_DONE
    v_and_b32 v190, 63, v0
    v_lshrrev_b32 v191, 6, v0
    s_nop 0
    v_readfirstlane_b32 s21, v191
    s_and_b32 s3, s2, 7
    s_lshr_b32 s4, s2, 3
    s_and_b32 s22, s4, 3
    s_lshl_b32 s3, s3, 2
    s_add_u32 s22, s22, s3
    s_lshr_b32 s23, s4, 2
    s_load_dwordx2 s[28:29], s[0:1], 16
    s_load_dwordx4 s[32:35], s[0:1], 56
    s_load_dwordx2 s[36:37], s[0:1], 96
    v_mov_b32 v253, v190
    s_lshr_b32 s65, s21, 2
    s_and_b32 s66, s21, 3
    s_sub_u32 s57, 15, s23
    s_add_u32 s58, s57, 1
    v_and_b32 v191, 15, v190
    v_lshrrev_b32 v193, 4, v190
    v_bfe_u32 v194, v190, 4, 1
    v_bfe_u32 v192, v191, 1, 3
    v_xor_b32 v192, v192, v193
    v_lshlrev_b32 v192, 4, v192
    v_lshl_or_b32 v192, v191, 7, v192
    s_lshr_b32 s3, s21, 2
    s_lshl_b32 s3, s3, 14
    v_add_u32 v176, s3, v192
    v_bfe_u32 v191, v190, 2, 2
    v_lshl_add_u32 v192, v193, 3, v191
    v_lshlrev_b32 v195, 7, v192
    v_bfe_u32 v192, v190, 3, 1
    v_lshl_or_b32 v195, v192, 6, v195
    v_and_b32 v191, 3, v190
    v_and_b32 v192, 1, v190
    v_xor_b32 v193, v191, v194
    v_lshlrev_b32 v193, 1, v193
    v_or_b32 v193, v193, v192
    v_lshl_or_b32 v195, v193, 3, v195
    s_lshl_b32 s3, s66, 13
    s_and_b32 s4, s66, 1
    s_lshl_b32 s4, s4, 6
    s_cmp_lt_u32 s66, 2
    s_cselect_b32 s3, s3, 0x4000
    s_cselect_b32 s4, 0, s4
    s_cselect_b32 s5, 64, 0x2000
    s_add_u32 s3, s3, 0x10000
    v_xor_b32 v180, s4, v195
    v_add_u32 v180, s3, v180
    v_xor_b32 v181, s5, v180
    s_cmp_lt_u32 s21, 4
    s_cselect_b32 s5, s57, s23
    s_mov_b32 s6, 3456
    s_cselect_b32 s6, 8192, s6
    s_lshl_b32 s5, s5, 7
    s_lshl_b32 s7, s66, 5
    s_add_u32 s5, s5, s7
    s_bfe_u32 s7, s21, 0x10001
    s_lshl_b32 s7, s7, 7
    s_lshl_b32 s38, s22, 8
    s_add_u32 s7, s7, s38
    s_lshl_b32 s38, s22, 7
    s_cmp_lt_u32 s21, 4
    s_cselect_b32 s7, s7, s38
    v_lshrrev_b32 v191, 3, v190
    v_and_b32 v192, 7, v190
    v_lshrrev_b32 v193, 4, v190
    v_xor_b32 v193, v192, v193
    v_add_u32 v194, s5, v191
    s_mov_b32 s3, 1280
    v_mul_lo_u32 v194, v194, s3
    v_lshl_add_u32 v182, v193, 4, v194
    v_xor_b32 v196, 4, v193
    v_lshl_add_u32 v183, v196, 4, v194
    v_add_u32 v183, 9216, v183
    v_lshl_add_u32 v184, v193, 4, v194
    v_add_u32 v184, 18432, v184
    v_xor_b32 v196, 4, v193
    v_lshl_add_u32 v185, v196, 4, v194
    v_add_u32 v185, 27648, v185
    v_bfe_u32 v193, v190, 4, 1
    v_lshlrev_b32 v193, 2, v193
    v_xor_b32 v193, v192, v193
    s_and_b32 s3, s21, 1
    s_lshl_b32 s3, s3, 5
    v_add_u32 v194, s3, v191
    v_mul_lo_u32 v194, v194, s6
    v_lshl_add_u32 v194, v193, 4, v194
    v_add_u32 v186, s7, v194
    s_lshl_b32 s3, s6, 3
    s_sub_u32 s3, s3, 1024
    v_add_u32 v187, s3, v186
    v_add_u32 v188, s3, v187
    v_add_u32 v189, s3, v188
    v_xor_b32 v187, 16, v187
    v_xor_b32 v189, 16, v189
    s_lshl_b32 s18, s6, 6
    s_lshr_b32 s3, s2, 3
    s_lshl_b32 s3, s3, 3
    s_add_u32 s3, s3, s21
    s_lshl_b32 s3, s3, 3
    v_bfe_u32 v191, v190, 2, 3
    v_add_u32 v191, s3, v191
    v_mul_u32_u24 v191, 1280, v191
    v_and_b32 v192, 3, v190
    v_lshl_add_u32 v198, v192, 6, v191
    s_and_b32 s3, s21, 1
    s_lshl_b32 s4, s23, 1
    s_add_u32 s3, s3, s4
    s_lshl_b32 s3, s3, 3
    s_add_u32 s3, s3, 64
    v_bfe_u32 v191, v190, 1, 3
    v_add_u32 v191, s3, v191
    v_mul_lo_u32 v191, v191, s6
    v_and_b32 v192, 1, v190
    v_lshl_add_u32 v191, v192, 6, v191
    v_add_u32 v199, s7, v191
    s_lshl_b32 s19, s21, 12
    s_add_u32 s20, s19, 0x10000
    s_mov_b32 s16, 0
    s_mov_b32 s17, 0
    s_waitcnt lgkmcnt(0)
    s_mov_b32 s8, s36
    s_and_b32 s9, s37, 0xffff
    s_mov_b32 s10, 2621440
    s_mov_b32 s11, 0x20000
    s_cmp_lt_u32 s21, 6
    s_cselect_b32 s38, s32, s34
    s_cselect_b32 s39, s33, s35
    s_cmp_lt_u32 s22, 27
    s_cselect_b32 s40, 2211840, 0
    s_cmp_lt_u32 s21, 4
    s_cselect_b32 s38, s28, s38
    s_cselect_b32 s39, s29, s39
    s_cselect_b32 s40, 5242880, s40
    s_mov_b32 s12, s38
    s_and_b32 s13, s39, 0xffff
    s_mov_b32 s14, s40
    s_mov_b32 s15, 0x20000
    s_add_u32 m0, s19, 0
    s_nop 0
    buffer_load_dwordx4 v182, s[8:11], s16 offen offset:0 lds
    buffer_load_dwordx4 v183, s[8:11], s16 offen offset:1024 lds
    buffer_load_dwordx4 v184, s[8:11], s16 offen offset:2048 lds
    buffer_load_dwordx4 v185, s[8:11], s16 offen offset:3072 lds
    s_add_u32 m0, s20, 0
    s_add_u32 s16, s16, 128
    buffer_load_dwordx4 v186, s[12:15], s17 offen offset:0 lds
    buffer_load_dwordx4 v187, s[12:15], s17 offen offset:1024 lds
    buffer_load_dwordx4 v188, s[12:15], s17 offen offset:2048 lds
    buffer_load_dwordx4 v189, s[12:15], s17 offen offset:3072 lds
    s_add_u32 s17, s17, s18
    s_add_u32 m0, s19, 32768
    s_nop 0
    buffer_load_dwordx4 v182, s[8:11], s16 offen offset:0 lds
    buffer_load_dwordx4 v183, s[8:11], s16 offen offset:1024 lds
    buffer_load_dwordx4 v184, s[8:11], s16 offen offset:2048 lds
    buffer_load_dwordx4 v185, s[8:11], s16 offen offset:3072 lds
    s_add_u32 s16, s16, 128
    s_lshl_b32 s39, s22, 19
    s_add_u32 s38, s39, 4194304
    s_add_u32 s44, s36, s38
    s_addc_u32 s45, s37, 0
    s_and_b32 s45, s45, 0xffff
    s_mov_b32 s46, 524288
    s_mov_b32 s47, 0x20000
    s_add_u32 s38, s39, 20971520
    s_add_u32 s48, s36, s38
    s_addc_u32 s49, s37, 0
    s_and_b32 s49, s49, 0xffff
    s_mov_b32 s50, 524288
    s_mov_b32 s51, 0x20000
    s_add_u32 s52, s36, 37748736
    s_addc_u32 s53, s37, 0
    s_and_b32 s53, s53, 0xffff
    s_mov_b32 s54, 23855104
    s_mov_b32 s55, 0x20000
    s_lshl_b32 s61, s65, 14
    s_mov_b32 s59, s61
    s_mov_b32 s60, s61
    s_lshl_b32 s3, s65, 16
    s_lshl_b32 s4, s66, 12
    s_add_u32 s62, s3, s4
    v_lshl_add_u32 v240, v253, 4, s3
    v_lshl_add_u32 v241, v253, 4, s4
    s_mov_b32 s64, 0x41000000
    s_mov_b32 s68, 0xf149f2ca
    s_mov_b32 s56, 0
    s_mov_b32 s67, s57
    v_and_b32 v245, 31, v253
    v_lshrrev_b32 v246, 5, v253
    v_lshlrev_b32 v247, 3, v246
    v_sub_u32 v245, v245, v247
    s_lshl_b32 s3, s66, 5
    s_lshl_b32 s4, s65, 6
    s_sub_u32 s3, s3, s4
    v_add_u32 v245, s3, v245
    v_bfe_u32 v247, v253, 4, 1
    v_mul_u32_u24 v252, 186368, v247
    v_lshl_add_u32 v252, v246, 8, v252
    v_and_b32 v247, 15, v253
    v_lshl_add_u32 v252, v247, 4, v252
    v_mov_b64 v[0:1], 0
    v_mov_b64 v[2:3], 0
    v_mov_b64 v[4:5], 0
    v_mov_b64 v[6:7], 0
    v_mov_b64 v[8:9], 0
    v_mov_b64 v[10:11], 0
    v_mov_b64 v[12:13], 0
    v_mov_b64 v[14:15], 0
    v_mov_b64 v[16:17], 0
    v_mov_b64 v[18:19], 0
    v_mov_b64 v[20:21], 0
    v_mov_b64 v[22:23], 0
    v_mov_b64 v[24:25], 0
    v_mov_b64 v[26:27], 0
    v_mov_b64 v[28:29], 0
    v_mov_b64 v[30:31], 0
    v_mov_b64 v[32:33], 0
    v_mov_b64 v[34:35], 0
    v_mov_b64 v[36:37], 0
    v_mov_b64 v[38:39], 0
    v_mov_b64 v[40:41], 0
    v_mov_b64 v[42:43], 0
    v_mov_b64 v[44:45], 0
    v_mov_b64 v[46:47], 0
    v_mov_b64 v[48:49], 0
    v_mov_b64 v[50:51], 0
    v_mov_b64 v[52:53], 0
    v_mov_b64 v[54:55], 0
    v_mov_b64 v[56:57], 0
    v_mov_b64 v[58:59], 0
    v_mov_b64 v[60:61], 0
    v_mov_b64 v[62:63], 0
    v_mov_b64 v[64:65], 0
    v_mov_b64 v[66:67], 0
    v_mov_b64 v[68:69], 0
    v_mov_b64 v[70:71], 0
    v_mov_b64 v[72:73], 0
    v_mov_b64 v[74:75], 0
    v_mov_b64 v[76:77], 0
    v_mov_b64 v[78:79], 0
    v_mov_b64 v[80:81], 0
    v_mov_b64 v[82:83], 0
    v_mov_b64 v[84:85], 0
    v_mov_b64 v[86:87], 0
    v_mov_b64 v[88:89], 0
    v_mov_b64 v[90:91], 0
    v_mov_b64 v[92:93], 0
    v_mov_b64 v[94:95], 0
    v_mov_b64 v[96:97], 0
    v_mov_b64 v[98:99], 0
    v_mov_b64 v[100:101], 0
    v_mov_b64 v[102:103], 0
    v_mov_b64 v[104:105], 0
    v_mov_b64 v[106:107], 0
    v_mov_b64 v[108:109], 0
    v_mov_b64 v[110:111], 0
    v_mov_b64 v[112:113], 0
    v_mov_b64 v[114:115], 0
    v_mov_b64 v[116:117], 0
    v_mov_b64 v[118:119], 0
    v_mov_b64 v[120:121], 0
    v_mov_b64 v[122:123], 0
    v_mov_b64 v[124:125], 0
    v_mov_b64 v[126:127], 0
    s_waitcnt vmcnt(4)
    s_barrier
    v_xor_b32 v177, 2048, v176
    v_xor_b32 v178, 64, v176
    v_xor_b32 v179, 2112, v176
    v_xor_b32 v224, 8, v180
    v_xor_b32 v225, 8, v181
    ds_read_b64_tr_b16 v[160:161], v180 offset:0
    ds_read_b64_tr_b16 v[162:163], v180 offset:512
    ds_read_b128 v[128:131], v176 offset:0
    ds_read_b128 v[132:135], v177 offset:0
    ds_read_b64_tr_b16 v[164:165], v224 offset:0
    ds_read_b64_tr_b16 v[166:167], v224 offset:512
    ds_read_b64_tr_b16 v[168:169], v181 offset:0
    ds_read_b64_tr_b16 v[170:171], v181 offset:512
    ds_read_b128 v[136:139], v176 offset:4096
    ds_read_b128 v[140:143], v177 offset:4096
    ds_read_b64_tr_b16 v[172:173], v225 offset:0
    ds_read_b64_tr_b16 v[174:175], v225 offset:512
    buffer_load_dword v197, v198, s[8:11], s16 offen
    buffer_load_dword v197, v199, s[12:15], s17 offen
    s_mov_b32 s69, 5
K2_G:
    s_cmp_eq_u32 s69, 1
    s_cselect_b32 s10, 0, s10
    s_waitcnt lgkmcnt(0)
    v_mfma_f32_16x16x32_bf16 v[0:3], v[160:163], v[128:131], v[0:3]
    s_add_u32 m0, s20, 32768
    v_mfma_f32_16x16x32_bf16 v[8:11], v[160:163], v[132:135], v[8:11]
    ds_read_b64_tr_b16 v[208:209], v180 offset:4096
    v_mfma_f32_16x16x32_bf16 v[32:35], v[160:163], v[136:139], v[32:35]
    buffer_load_dwordx4 v186, s[12:15], s17 offen offset:0 lds
    v_mfma_f32_16x16x32_bf16 v[40:43], v[160:163], v[140:143], v[40:43]
    ds_read_b64_tr_b16 v[210:211], v180 offset:4608
    v_mfma_f32_16x16x32_bf16 v[4:7], v[164:167], v[128:131], v[4:7]
    ds_read_b128 v[144:147], v176 offset:8192
    v_mfma_f32_16x16x32_bf16 v[12:15], v[164:167], v[132:135], v[12:15]
    buffer_load_dwordx4 v187, s[12:15], s17 offen offset:1024 lds
    v_mfma_f32_16x16x32_bf16 v[36:39], v[164:167], v[136:139], v[36:39]
    ds_read_b128 v[148:151], v177 offset:8192
    v_mfma_f32_16x16x32_bf16 v[44:47], v[164:167], v[140:143], v[44:47]
    buffer_load_dwordx4 v188, s[12:15], s17 offen offset:2048 lds
    v_mfma_f32_16x16x32_bf16 v[16:19], v[168:171], v[128:131], v[16:19]
    ds_read_b64_tr_b16 v[212:213], v224 offset:4096
    v_mfma_f32_16x16x32_bf16 v[24:27], v[168:171], v[132:135], v[24:27]
    ds_read_b64_tr_b16 v[214:215], v224 offset:4608
    v_mfma_f32_16x16x32_bf16 v[48:51], v[168:171], v[136:139], v[48:51]
    buffer_load_dwordx4 v189, s[12:15], s17 offen offset:3072 lds
    v_mfma_f32_16x16x32_bf16 v[56:59], v[168:171], v[140:143], v[56:59]
    ds_read_b128 v[152:155], v176 offset:12288
    v_mfma_f32_16x16x32_bf16 v[20:23], v[172:175], v[128:131], v[20:23]
    ds_read_b128 v[156:159], v177 offset:12288
    v_mfma_f32_16x16x32_bf16 v[28:31], v[172:175], v[132:135], v[28:31]
    s_add_u32 s17, s17, s18
    v_mfma_f32_16x16x32_bf16 v[52:55], v[172:175], v[136:139], v[52:55]
    s_cmp_eq_u32 s69, 1
    v_mfma_f32_16x16x32_bf16 v[60:63], v[172:175], v[140:143], v[60:63]
    s_cselect_b32 s14, 0, s14
    s_waitcnt lgkmcnt(0)
    v_mfma_f32_16x16x32_bf16 v[64:67], v[160:163], v[144:147], v[64:67]
    ds_read_b64_tr_b16 v[216:217], v181 offset:4096
    v_mfma_f32_16x16x32_bf16 v[72:75], v[160:163], v[148:151], v[72:75]
    ds_read_b64_tr_b16 v[218:219], v181 offset:4608
    v_mfma_f32_16x16x32_bf16 v[96:99], v[160:163], v[152:155], v[96:99]
    v_mfma_f32_16x16x32_bf16 v[104:107], v[160:163], v[156:159], v[104:107]
    ds_read_b128 v[128:131], v178 offset:0
    v_mfma_f32_16x16x32_bf16 v[68:71], v[164:167], v[144:147], v[68:71]
    v_mfma_f32_16x16x32_bf16 v[76:79], v[164:167], v[148:151], v[76:79]
    ds_read_b128 v[132:135], v179 offset:0
    v_mfma_f32_16x16x32_bf16 v[100:103], v[164:167], v[152:155], v[100:103]
    v_mfma_f32_16x16x32_bf16 v[108:111], v[164:167], v[156:159], v[108:111]
    ds_read_b64_tr_b16 v[220:221], v225 offset:4096
    v_mfma_f32_16x16x32_bf16 v[80:83], v[168:171], v[144:147], v[80:83]
    ds_read_b64_tr_b16 v[222:223], v225 offset:4608
    v_mfma_f32_16x16x32_bf16 v[88:91], v[168:171], v[148:151], v[88:91]
    v_mfma_f32_16x16x32_bf16 v[112:115], v[168:171], v[152:155], v[112:115]
    ds_read_b128 v[136:139], v178 offset:4096
    v_mfma_f32_16x16x32_bf16 v[120:123], v[168:171], v[156:159], v[120:123]
    v_mfma_f32_16x16x32_bf16 v[84:87], v[172:175], v[144:147], v[84:87]
    ds_read_b128 v[140:143], v179 offset:4096
    v_mfma_f32_16x16x32_bf16 v[92:95], v[172:175], v[148:151], v[92:95]
    v_mfma_f32_16x16x32_bf16 v[116:119], v[172:175], v[152:155], v[116:119]
    buffer_load_dword v197, v198, s[8:11], s16 offen offset:256
    v_mfma_f32_16x16x32_bf16 v[124:127], v[172:175], v[156:159], v[124:127]
    s_waitcnt lgkmcnt(0)
    v_mfma_f32_16x16x32_bf16 v[0:3], v[208:211], v[128:131], v[0:3]
    ds_read_b128 v[144:147], v178 offset:8192
    v_mfma_f32_16x16x32_bf16 v[8:11], v[208:211], v[132:135], v[8:11]
    v_mfma_f32_16x16x32_bf16 v[32:35], v[208:211], v[136:139], v[32:35]
    v_mfma_f32_16x16x32_bf16 v[40:43], v[208:211], v[140:143], v[40:43]
    v_mfma_f32_16x16x32_bf16 v[4:7], v[212:215], v[128:131], v[4:7]
    ds_read_b128 v[148:151], v179 offset:8192
    v_mfma_f32_16x16x32_bf16 v[12:15], v[212:215], v[132:135], v[12:15]
    v_mfma_f32_16x16x32_bf16 v[36:39], v[212:215], v[136:139], v[36:39]
    v_mfma_f32_16x16x32_bf16 v[44:47], v[212:215], v[140:143], v[44:47]
    v_mfma_f32_16x16x32_bf16 v[16:19], v[216:219], v[128:131], v[16:19]
    ds_read_b128 v[152:155], v178 offset:12288
    v_mfma_f32_16x16x32_bf16 v[24:27], v[216:219], v[132:135], v[24:27]
    v_mfma_f32_16x16x32_bf16 v[48:51], v[216:219], v[136:139], v[48:51]
    v_mfma_f32_16x16x32_bf16 v[56:59], v[216:219], v[140:143], v[56:59]
    v_mfma_f32_16x16x32_bf16 v[20:23], v[220:223], v[128:131], v[20:23]
    ds_read_b128 v[156:159], v179 offset:12288
    v_mfma_f32_16x16x32_bf16 v[28:31], v[220:223], v[132:135], v[28:31]
    v_mfma_f32_16x16x32_bf16 v[52:55], v[220:223], v[136:139], v[52:55]
    v_mfma_f32_16x16x32_bf16 v[60:63], v[220:223], v[140:143], v[60:63]
    s_waitcnt vmcnt(1) lgkmcnt(0)
    s_barrier
    v_mfma_f32_16x16x32_bf16 v[64:67], v[208:211], v[144:147], v[64:67]
    s_add_u32 m0, s19, 0
    ds_read_b64_tr_b16 v[160:161], v180 offset:32768
    v_mfma_f32_16x16x32_bf16 v[72:75], v[208:211], v[148:151], v[72:75]
    ds_read_b64_tr_b16 v[162:163], v180 offset:33280
    v_mfma_f32_16x16x32_bf16 v[96:99], v[208:211], v[152:155], v[96:99]
    buffer_load_dwordx4 v182, s[8:11], s16 offen offset:0 lds
    v_mfma_f32_16x16x32_bf16 v[104:107], v[208:211], v[156:159], v[104:107]
    ds_read_b128 v[128:131], v176 offset:32768
    v_mfma_f32_16x16x32_bf16 v[68:71], v[212:215], v[144:147], v[68:71]
    ds_read_b128 v[132:135], v177 offset:32768
    v_mfma_f32_16x16x32_bf16 v[76:79], v[212:215], v[148:151], v[76:79]
    buffer_load_dwordx4 v183, s[8:11], s16 offen offset:1024 lds
    v_mfma_f32_16x16x32_bf16 v[100:103], v[212:215], v[152:155], v[100:103]
    ds_read_b64_tr_b16 v[164:165], v224 offset:32768
    v_mfma_f32_16x16x32_bf16 v[108:111], v[212:215], v[156:159], v[108:111]
    ds_read_b64_tr_b16 v[166:167], v224 offset:33280
    v_mfma_f32_16x16x32_bf16 v[80:83], v[216:219], v[144:147], v[80:83]
    ds_read_b64_tr_b16 v[168:169], v181 offset:32768
    buffer_load_dwordx4 v184, s[8:11], s16 offen offset:2048 lds
    v_mfma_f32_16x16x32_bf16 v[88:91], v[216:219], v[148:151], v[88:91]
    ds_read_b64_tr_b16 v[170:171], v181 offset:33280
    v_mfma_f32_16x16x32_bf16 v[112:115], v[216:219], v[152:155], v[112:115]
    ds_read_b128 v[136:139], v176 offset:36864
    v_mfma_f32_16x16x32_bf16 v[120:123], v[216:219], v[156:159], v[120:123]
    buffer_load_dwordx4 v185, s[8:11], s16 offen offset:3072 lds
    v_mfma_f32_16x16x32_bf16 v[84:87], v[220:223], v[144:147], v[84:87]
    ds_read_b128 v[140:143], v177 offset:36864
    v_mfma_f32_16x16x32_bf16 v[92:95], v[220:223], v[148:151], v[92:95]
    ds_read_b64_tr_b16 v[172:173], v225 offset:32768
    v_mfma_f32_16x16x32_bf16 v[116:119], v[220:223], v[152:155], v[116:119]
    ds_read_b64_tr_b16 v[174:175], v225 offset:33280
    v_mfma_f32_16x16x32_bf16 v[124:127], v[220:223], v[156:159], v[124:127]
    s_add_u32 s16, s16, 128
    s_waitcnt lgkmcnt(0)
    v_mfma_f32_16x16x32_bf16 v[0:3], v[160:163], v[128:131], v[0:3]
    s_add_u32 m0, s20, 0
    v_mfma_f32_16x16x32_bf16 v[8:11], v[160:163], v[132:135], v[8:11]
    ds_read_b64_tr_b16 v[208:209], v180 offset:36864
    v_mfma_f32_16x16x32_bf16 v[32:35], v[160:163], v[136:139], v[32:35]
    buffer_load_dwordx4 v186, s[12:15], s17 offen offset:0 lds
    v_mfma_f32_16x16x32_bf16 v[40:43], v[160:163], v[140:143], v[40:43]
    ds_read_b64_tr_b16 v[210:211], v180 offset:37376
    v_mfma_f32_16x16x32_bf16 v[4:7], v[164:167], v[128:131], v[4:7]
    ds_read_b128 v[144:147], v176 offset:40960
    v_mfma_f32_16x16x32_bf16 v[12:15], v[164:167], v[132:135], v[12:15]
    buffer_load_dwordx4 v187, s[12:15], s17 offen offset:1024 lds
    v_mfma_f32_16x16x32_bf16 v[36:39], v[164:167], v[136:139], v[36:39]
    ds_read_b128 v[148:151], v177 offset:40960
    v_mfma_f32_16x16x32_bf16 v[44:47], v[164:167], v[140:143], v[44:47]
    v_mfma_f32_16x16x32_bf16 v[16:19], v[168:171], v[128:131], v[16:19]
    buffer_load_dwordx4 v188, s[12:15], s17 offen offset:2048 lds
    v_mfma_f32_16x16x32_bf16 v[24:27], v[168:171], v[132:135], v[24:27]
    ds_read_b64_tr_b16 v[212:213], v224 offset:36864
    v_mfma_f32_16x16x32_bf16 v[48:51], v[168:171], v[136:139], v[48:51]
    ds_read_b64_tr_b16 v[214:215], v224 offset:37376
    v_mfma_f32_16x16x32_bf16 v[56:59], v[168:171], v[140:143], v[56:59]
    buffer_load_dwordx4 v189, s[12:15], s17 offen offset:3072 lds
    v_mfma_f32_16x16x32_bf16 v[20:23], v[172:175], v[128:131], v[20:23]
    ds_read_b128 v[152:155], v176 offset:45056
    v_mfma_f32_16x16x32_bf16 v[28:31], v[172:175], v[132:135], v[28:31]
    ds_read_b128 v[156:159], v177 offset:45056
    v_mfma_f32_16x16x32_bf16 v[52:55], v[172:175], v[136:139], v[52:55]
    s_add_u32 s17, s17, s18
    v_mfma_f32_16x16x32_bf16 v[60:63], v[172:175], v[140:143], v[60:63]
    s_waitcnt lgkmcnt(0)
    v_mfma_f32_16x16x32_bf16 v[64:67], v[160:163], v[144:147], v[64:67]
    ds_read_b64_tr_b16 v[216:217], v181 offset:36864
    v_mfma_f32_16x16x32_bf16 v[72:75], v[160:163], v[148:151], v[72:75]
    ds_read_b64_tr_b16 v[218:219], v181 offset:37376
    v_mfma_f32_16x16x32_bf16 v[96:99], v[160:163], v[152:155], v[96:99]
    v_mfma_f32_16x16x32_bf16 v[104:107], v[160:163], v[156:159], v[104:107]
    ds_read_b128 v[128:131], v178 offset:32768
    v_mfma_f32_16x16x32_bf16 v[68:71], v[164:167], v[144:147], v[68:71]
    v_mfma_f32_16x16x32_bf16 v[76:79], v[164:167], v[148:151], v[76:79]
    ds_read_b128 v[132:135], v179 offset:32768
    v_mfma_f32_16x16x32_bf16 v[100:103], v[164:167], v[152:155], v[100:103]
    v_mfma_f32_16x16x32_bf16 v[108:111], v[164:167], v[156:159], v[108:111]
    ds_read_b64_tr_b16 v[220:221], v225 offset:36864
    v_mfma_f32_16x16x32_bf16 v[80:83], v[168:171], v[144:147], v[80:83]
    ds_read_b64_tr_b16 v[222:223], v225 offset:37376
    v_mfma_f32_16x16x32_bf16 v[88:91], v[168:171], v[148:151], v[88:91]
    v_mfma_f32_16x16x32_bf16 v[112:115], v[168:171], v[152:155], v[112:115]
    ds_read_b128 v[136:139], v178 offset:36864
    v_mfma_f32_16x16x32_bf16 v[120:123], v[168:171], v[156:159], v[120:123]
    v_mfma_f32_16x16x32_bf16 v[84:87], v[172:175], v[144:147], v[84:87]
    ds_read_b128 v[140:143], v179 offset:36864
    v_mfma_f32_16x16x32_bf16 v[92:95], v[172:175], v[148:151], v[92:95]
    v_mfma_f32_16x16x32_bf16 v[116:119], v[172:175], v[152:155], v[116:119]
    buffer_load_dword v197, v199, s[12:15], s17 offen
    v_mfma_f32_16x16x32_bf16 v[124:127], v[172:175], v[156:159], v[124:127]
    s_waitcnt lgkmcnt(0)
    v_mfma_f32_16x16x32_bf16 v[0:3], v[208:211], v[128:131], v[0:3]
    ds_read_b128 v[144:147], v178 offset:40960
    v_mfma_f32_16x16x32_bf16 v[8:11], v[208:211], v[132:135], v[8:11]
    v_mfma_f32_16x16x32_bf16 v[32:35], v[208:211], v[136:139], v[32:35]
    v_mfma_f32_16x16x32_bf16 v[40:43], v[208:211], v[140:143], v[40:43]
    v_mfma_f32_16x16x32_bf16 v[4:7], v[212:215], v[128:131], v[4:7]
    ds_read_b128 v[148:151], v179 offset:40960
    v_mfma_f32_16x16x32_bf16 v[12:15], v[212:215], v[132:135], v[12:15]
    v_mfma_f32_16x16x32_bf16 v[36:39], v[212:215], v[136:139], v[36:39]
    v_mfma_f32_16x16x32_bf16 v[44:47], v[212:215], v[140:143], v[44:47]
    v_mfma_f32_16x16x32_bf16 v[16:19], v[216:219], v[128:131], v[16:19]
    ds_read_b128 v[152:155], v178 offset:45056
    v_mfma_f32_16x16x32_bf16 v[24:27], v[216:219], v[132:135], v[24:27]
    v_mfma_f32_16x16x32_bf16 v[48:51], v[216:219], v[136:139], v[48:51]
    v_mfma_f32_16x16x32_bf16 v[56:59], v[216:219], v[140:143], v[56:59]
    v_mfma_f32_16x16x32_bf16 v[20:23], v[220:223], v[128:131], v[20:23]
    ds_read_b128 v[156:159], v179 offset:45056
    v_mfma_f32_16x16x32_bf16 v[28:31], v[220:223], v[132:135], v[28:31]
    v_mfma_f32_16x16x32_bf16 v[52:55], v[220:223], v[136:139], v[52:55]
    v_mfma_f32_16x16x32_bf16 v[60:63], v[220:223], v[140:143], v[60:63]
    s_waitcnt vmcnt(1) lgkmcnt(0)
    s_barrier
    v_mfma_f32_16x16x32_bf16 v[64:67], v[208:211], v[144:147], v[64:67]
    s_add_u32 m0, s19, 32768
    ds_read_b64_tr_b16 v[160:161], v180 offset:0
    v_mfma_f32_16x16x32_bf16 v[72:75], v[208:211], v[148:151], v[72:75]
    ds_read_b64_tr_b16 v[162:163], v180 offset:512
    v_mfma_f32_16x16x32_bf16 v[96:99], v[208:211], v[152:155], v[96:99]
    buffer_load_dwordx4 v182, s[8:11], s16 offen offset:0 lds
    v_mfma_f32_16x16x32_bf16 v[104:107], v[208:211], v[156:159], v[104:107]
    ds_read_b128 v[128:131], v176 offset:0
    v_mfma_f32_16x16x32_bf16 v[68:71], v[212:215], v[144:147], v[68:71]
    ds_read_b128 v[132:135], v177 offset:0
    v_mfma_f32_16x16x32_bf16 v[76:79], v[212:215], v[148:151], v[76:79]
    buffer_load_dwordx4 v183, s[8:11], s16 offen offset:1024 lds
    v_mfma_f32_16x16x32_bf16 v[100:103], v[212:215], v[152:155], v[100:103]
    ds_read_b64_tr_b16 v[164:165], v224 offset:0
    v_mfma_f32_16x16x32_bf16 v[108:111], v[212:215], v[156:159], v[108:111]
    ds_read_b64_tr_b16 v[166:167], v224 offset:512
    v_mfma_f32_16x16x32_bf16 v[80:83], v[216:219], v[144:147], v[80:83]
    ds_read_b64_tr_b16 v[168:169], v181 offset:0
    buffer_load_dwordx4 v184, s[8:11], s16 offen offset:2048 lds
    v_mfma_f32_16x16x32_bf16 v[88:91], v[216:219], v[148:151], v[88:91]
    ds_read_b64_tr_b16 v[170:171], v181 offset:512
    v_mfma_f32_16x16x32_bf16 v[112:115], v[216:219], v[152:155], v[112:115]
    ds_read_b128 v[136:139], v176 offset:4096
    v_mfma_f32_16x16x32_bf16 v[120:123], v[216:219], v[156:159], v[120:123]
    buffer_load_dwordx4 v185, s[8:11], s16 offen offset:3072 lds
    v_mfma_f32_16x16x32_bf16 v[84:87], v[220:223], v[144:147], v[84:87]
    ds_read_b128 v[140:143], v177 offset:4096
    v_mfma_f32_16x16x32_bf16 v[92:95], v[220:223], v[148:151], v[92:95]
    ds_read_b64_tr_b16 v[172:173], v225 offset:0
    v_mfma_f32_16x16x32_bf16 v[116:119], v[220:223], v[152:155], v[116:119]
    ds_read_b64_tr_b16 v[174:175], v225 offset:512
    v_mfma_f32_16x16x32_bf16 v[124:127], v[220:223], v[156:159], v[124:127]
    s_add_u32 s16, s16, 128
    s_sub_u32 s69, s69, 1
    s_cmp_lg_u32 s69, 1
    s_cbranch_scc1 K2_G
    s_waitcnt lgkmcnt(0)
    v_mfma_f32_16x16x32_bf16 v[0:3], v[160:163], v[128:131], v[0:3]
    s_add_u32 m0, s20, 32768
    v_mfma_f32_16x16x32_bf16 v[8:11], v[160:163], v[132:135], v[8:11]
    ds_read_b64_tr_b16 v[208:209], v180 offset:4096
    v_mfma_f32_16x16x32_bf16 v[32:35], v[160:163], v[136:139], v[32:35]
    buffer_load_dwordx4 v186, s[12:15], s17 offen offset:0 lds
    v_mfma_f32_16x16x32_bf16 v[40:43], v[160:163], v[140:143], v[40:43]
    ds_read_b64_tr_b16 v[210:211], v180 offset:4608
    v_mfma_f32_16x16x32_bf16 v[4:7], v[164:167], v[128:131], v[4:7]
    ds_read_b128 v[144:147], v176 offset:8192
    v_mfma_f32_16x16x32_bf16 v[12:15], v[164:167], v[132:135], v[12:15]
    buffer_load_dwordx4 v187, s[12:15], s17 offen offset:1024 lds
    v_mfma_f32_16x16x32_bf16 v[36:39], v[164:167], v[136:139], v[36:39]
    ds_read_b128 v[148:151], v177 offset:8192
    v_mfma_f32_16x16x32_bf16 v[44:47], v[164:167], v[140:143], v[44:47]
    v_mfma_f32_16x16x32_bf16 v[16:19], v[168:171], v[128:131], v[16:19]
    buffer_load_dwordx4 v188, s[12:15], s17 offen offset:2048 lds
    v_mfma_f32_16x16x32_bf16 v[24:27], v[168:171], v[132:135], v[24:27]
    ds_read_b64_tr_b16 v[212:213], v224 offset:4096
    v_mfma_f32_16x16x32_bf16 v[48:51], v[168:171], v[136:139], v[48:51]
    ds_read_b64_tr_b16 v[214:215], v224 offset:4608
    v_mfma_f32_16x16x32_bf16 v[56:59], v[168:171], v[140:143], v[56:59]
    buffer_load_dwordx4 v189, s[12:15], s17 offen offset:3072 lds
    v_mfma_f32_16x16x32_bf16 v[20:23], v[172:175], v[128:131], v[20:23]
    ds_read_b128 v[152:155], v176 offset:12288
    v_mfma_f32_16x16x32_bf16 v[28:31], v[172:175], v[132:135], v[28:31]
    ds_read_b128 v[156:159], v177 offset:12288
    v_mfma_f32_16x16x32_bf16 v[52:55], v[172:175], v[136:139], v[52:55]
    s_add_u32 s17, s17, s18
    v_mfma_f32_16x16x32_bf16 v[60:63], v[172:175], v[140:143], v[60:63]
    s_waitcnt lgkmcnt(0)
    v_mfma_f32_16x16x32_bf16 v[64:67], v[160:163], v[144:147], v[64:67]
    ds_read_b64_tr_b16 v[216:217], v181 offset:4096
    v_mfma_f32_16x16x32_bf16 v[72:75], v[160:163], v[148:151], v[72:75]
    v_mfma_f32_16x16x32_bf16 v[96:99], v[160:163], v[152:155], v[96:99]
    ds_read_b64_tr_b16 v[218:219], v181 offset:4608
    v_mfma_f32_16x16x32_bf16 v[104:107], v[160:163], v[156:159], v[104:107]
    v_mfma_f32_16x16x32_bf16 v[68:71], v[164:167], v[144:147], v[68:71]
    ds_read_b128 v[128:131], v178 offset:0
    v_mfma_f32_16x16x32_bf16 v[76:79], v[164:167], v[148:151], v[76:79]
    v_mfma_f32_16x16x32_bf16 v[100:103], v[164:167], v[152:155], v[100:103]
    ds_read_b128 v[132:135], v179 offset:0
    v_mfma_f32_16x16x32_bf16 v[108:111], v[164:167], v[156:159], v[108:111]
    v_mfma_f32_16x16x32_bf16 v[80:83], v[168:171], v[144:147], v[80:83]
    ds_read_b64_tr_b16 v[220:221], v225 offset:4096
    v_mfma_f32_16x16x32_bf16 v[88:91], v[168:171], v[148:151], v[88:91]
    v_mfma_f32_16x16x32_bf16 v[112:115], v[168:171], v[152:155], v[112:115]
    ds_read_b64_tr_b16 v[222:223], v225 offset:4608
    v_mfma_f32_16x16x32_bf16 v[120:123], v[168:171], v[156:159], v[120:123]
    v_mfma_f32_16x16x32_bf16 v[84:87], v[172:175], v[144:147], v[84:87]
    ds_read_b128 v[136:139], v178 offset:4096
    v_mfma_f32_16x16x32_bf16 v[92:95], v[172:175], v[148:151], v[92:95]
    v_mfma_f32_16x16x32_bf16 v[116:119], v[172:175], v[152:155], v[116:119]
    ds_read_b128 v[140:143], v179 offset:4096
    v_mfma_f32_16x16x32_bf16 v[124:127], v[172:175], v[156:159], v[124:127]
    s_waitcnt lgkmcnt(0)
    v_mfma_f32_16x16x32_bf16 v[0:3], v[208:211], v[128:131], v[0:3]
    ds_read_b128 v[144:147], v178 offset:8192
    v_mfma_f32_16x16x32_bf16 v[8:11], v[208:211], v[132:135], v[8:11]
    v_mfma_f32_16x16x32_bf16 v[32:35], v[208:211], v[136:139], v[32:35]
    v_mfma_f32_16x16x32_bf16 v[40:43], v[208:211], v[140:143], v[40:43]
    v_mfma_f32_16x16x32_bf16 v[4:7], v[212:215], v[128:131], v[4:7]
    ds_read_b128 v[148:151], v179 offset:8192
    v_mfma_f32_16x16x32_bf16 v[12:15], v[212:215], v[132:135], v[12:15]
    v_mfma_f32_16x16x32_bf16 v[36:39], v[212:215], v[136:139], v[36:39]
    v_mfma_f32_16x16x32_bf16 v[44:47], v[212:215], v[140:143], v[44:47]
    v_mfma_f32_16x16x32_bf16 v[16:19], v[216:219], v[128:131], v[16:19]
    ds_read_b128 v[152:155], v178 offset:12288
    v_mfma_f32_16x16x32_bf16 v[24:27], v[216:219], v[132:135], v[24:27]
    v_mfma_f32_16x16x32_bf16 v[48:51], v[216:219], v[136:139], v[48:51]
    v_mfma_f32_16x16x32_bf16 v[56:59], v[216:219], v[140:143], v[56:59]
    v_mfma_f32_16x16x32_bf16 v[20:23], v[220:223], v[128:131], v[20:23]
    ds_read_b128 v[156:159], v179 offset:12288
    v_mfma_f32_16x16x32_bf16 v[28:31], v[220:223], v[132:135], v[28:31]
    v_mfma_f32_16x16x32_bf16 v[52:55], v[220:223], v[136:139], v[52:55]
    v_mfma_f32_16x16x32_bf16 v[60:63], v[220:223], v[140:143], v[60:63]
    s_waitcnt vmcnt(0) lgkmcnt(0)
    s_barrier
    v_mfma_f32_16x16x32_bf16 v[64:67], v[208:211], v[144:147], v[64:67]
    s_add_u32 m0, s62, 0
    ds_read_b64_tr_b16 v[160:161], v180 offset:32768
    v_mfma_f32_16x16x32_bf16 v[72:75], v[208:211], v[148:151], v[72:75]
    ds_read_b64_tr_b16 v[162:163], v180 offset:33280
    v_mfma_f32_16x16x32_bf16 v[96:99], v[208:211], v[152:155], v[96:99]
    buffer_load_dwordx4 v241, s[44:47], s59 offen offset:0 lds
    v_mfma_f32_16x16x32_bf16 v[104:107], v[208:211], v[156:159], v[104:107]
    ds_read_b128 v[128:131], v176 offset:32768
    v_mfma_f32_16x16x32_bf16 v[68:71], v[212:215], v[144:147], v[68:71]
    ds_read_b128 v[132:135], v177 offset:32768
    v_mfma_f32_16x16x32_bf16 v[76:79], v[212:215], v[148:151], v[76:79]
    buffer_load_dwordx4 v241, s[44:47], s59 offen offset:1024 lds
    v_mfma_f32_16x16x32_bf16 v[100:103], v[212:215], v[152:155], v[100:103]
    ds_read_b64_tr_b16 v[164:165], v224 offset:32768
    v_mfma_f32_16x16x32_bf16 v[108:111], v[212:215], v[156:159], v[108:111]
    ds_read_b64_tr_b16 v[166:167], v224 offset:33280
    v_mfma_f32_16x16x32_bf16 v[80:83], v[216:219], v[144:147], v[80:83]
    ds_read_b64_tr_b16 v[168:169], v181 offset:32768
    buffer_load_dwordx4 v241, s[44:47], s59 offen offset:2048 lds
    v_mfma_f32_16x16x32_bf16 v[88:91], v[216:219], v[148:151], v[88:91]
    ds_read_b64_tr_b16 v[170:171], v181 offset:33280
    v_mfma_f32_16x16x32_bf16 v[112:115], v[216:219], v[152:155], v[112:115]
    ds_read_b128 v[136:139], v176 offset:36864
    v_mfma_f32_16x16x32_bf16 v[120:123], v[216:219], v[156:159], v[120:123]
    buffer_load_dwordx4 v241, s[44:47], s59 offen offset:3072 lds
    v_mfma_f32_16x16x32_bf16 v[84:87], v[220:223], v[144:147], v[84:87]
    ds_read_b128 v[140:143], v177 offset:36864
    v_mfma_f32_16x16x32_bf16 v[92:95], v[220:223], v[148:151], v[92:95]
    ds_read_b64_tr_b16 v[172:173], v225 offset:32768
    v_mfma_f32_16x16x32_bf16 v[116:119], v[220:223], v[152:155], v[116:119]
    ds_read_b64_tr_b16 v[174:175], v225 offset:33280
    v_mfma_f32_16x16x32_bf16 v[124:127], v[220:223], v[156:159], v[124:127]
    s_add_u32 s59, s59, 32768
    s_waitcnt lgkmcnt(0)
    v_mfma_f32_16x16x32_bf16 v[0:3], v[160:163], v[128:131], v[0:3]
    s_add_u32 m0, s62, 16384
    v_mfma_f32_16x16x32_bf16 v[8:11], v[160:163], v[132:135], v[8:11]
    ds_read_b64_tr_b16 v[208:209], v180 offset:36864
    v_mfma_f32_16x16x32_bf16 v[32:35], v[160:163], v[136:139], v[32:35]
    buffer_load_dwordx4 v241, s[44:47], s59 offen offset:0 lds
    v_mfma_f32_16x16x32_bf16 v[40:43], v[160:163], v[140:143], v[40:43]
    ds_read_b64_tr_b16 v[210:211], v180 offset:37376
    v_mfma_f32_16x16x32_bf16 v[4:7], v[164:167], v[128:131], v[4:7]
    ds_read_b128 v[144:147], v176 offset:40960
    v_mfma_f32_16x16x32_bf16 v[12:15], v[164:167], v[132:135], v[12:15]
    buffer_load_dwordx4 v241, s[44:47], s59 offen offset:1024 lds
    v_mfma_f32_16x16x32_bf16 v[36:39], v[164:167], v[136:139], v[36:39]
    ds_read_b128 v[148:151], v177 offset:40960
    v_mfma_f32_16x16x32_bf16 v[44:47], v[164:167], v[140:143], v[44:47]
    v_mfma_f32_16x16x32_bf16 v[16:19], v[168:171], v[128:131], v[16:19]
    buffer_load_dwordx4 v241, s[44:47], s59 offen offset:2048 lds
    v_mfma_f32_16x16x32_bf16 v[24:27], v[168:171], v[132:135], v[24:27]
    ds_read_b64_tr_b16 v[212:213], v224 offset:36864
    v_mfma_f32_16x16x32_bf16 v[48:51], v[168:171], v[136:139], v[48:51]
    ds_read_b64_tr_b16 v[214:215], v224 offset:37376
    v_mfma_f32_16x16x32_bf16 v[56:59], v[168:171], v[140:143], v[56:59]
    buffer_load_dwordx4 v241, s[44:47], s59 offen offset:3072 lds
    v_mfma_f32_16x16x32_bf16 v[20:23], v[172:175], v[128:131], v[20:23]
    ds_read_b128 v[152:155], v176 offset:45056
    v_mfma_f32_16x16x32_bf16 v[28:31], v[172:175], v[132:135], v[28:31]
    ds_read_b128 v[156:159], v177 offset:45056
    v_mfma_f32_16x16x32_bf16 v[52:55], v[172:175], v[136:139], v[52:55]
    s_add_u32 s59, s59, 32768
    v_mfma_f32_16x16x32_bf16 v[60:63], v[172:175], v[140:143], v[60:63]
    s_waitcnt lgkmcnt(0)
    v_mfma_f32_16x16x32_bf16 v[64:67], v[160:163], v[144:147], v[64:67]
    ds_read_b64_tr_b16 v[216:217], v181 offset:36864
    v_mfma_f32_16x16x32_bf16 v[72:75], v[160:163], v[148:151], v[72:75]
    v_mfma_f32_16x16x32_bf16 v[96:99], v[160:163], v[152:155], v[96:99]
    ds_read_b64_tr_b16 v[218:219], v181 offset:37376
    v_mfma_f32_16x16x32_bf16 v[104:107], v[160:163], v[156:159], v[104:107]
    v_mfma_f32_16x16x32_bf16 v[68:71], v[164:167], v[144:147], v[68:71]
    ds_read_b128 v[128:131], v178 offset:32768
    v_mfma_f32_16x16x32_bf16 v[76:79], v[164:167], v[148:151], v[76:79]
    v_mfma_f32_16x16x32_bf16 v[100:103], v[164:167], v[152:155], v[100:103]
    ds_read_b128 v[132:135], v179 offset:32768
    v_mfma_f32_16x16x32_bf16 v[108:111], v[164:167], v[156:159], v[108:111]
    v_mfma_f32_16x16x32_bf16 v[80:83], v[168:171], v[144:147], v[80:83]
    ds_read_b64_tr_b16 v[220:221], v225 offset:36864
    v_mfma_f32_16x16x32_bf16 v[88:91], v[168:171], v[148:151], v[88:91]
    v_mfma_f32_16x16x32_bf16 v[112:115], v[168:171], v[152:155], v[112:115]
    ds_read_b64_tr_b16 v[222:223], v225 offset:37376
    v_mfma_f32_16x16x32_bf16 v[120:123], v[168:171], v[156:159], v[120:123]
    v_mfma_f32_16x16x32_bf16 v[84:87], v[172:175], v[144:147], v[84:87]
    ds_read_b128 v[136:139], v178 offset:36864
    v_mfma_f32_16x16x32_bf16 v[92:95], v[172:175], v[148:151], v[92:95]
    v_mfma_f32_16x16x32_bf16 v[116:119], v[172:175], v[152:155], v[116:119]
    ds_read_b128 v[140:143], v179 offset:36864
    v_mfma_f32_16x16x32_bf16 v[124:127], v[172:175], v[156:159], v[124:127]
    s_waitcnt lgkmcnt(0)
    v_mfma_f32_16x16x32_bf16 v[0:3], v[208:211], v[128:131], v[0:3]
    ds_read_b128 v[144:147], v178 offset:40960
    v_mfma_f32_16x16x32_bf16 v[8:11], v[208:211], v[132:135], v[8:11]
    v_mfma_f32_16x16x32_bf16 v[32:35], v[208:211], v[136:139], v[32:35]
    v_mfma_f32_16x16x32_bf16 v[40:43], v[208:211], v[140:143], v[40:43]
    v_mfma_f32_16x16x32_bf16 v[4:7], v[212:215], v[128:131], v[4:7]
    ds_read_b128 v[148:151], v179 offset:40960
    v_mfma_f32_16x16x32_bf16 v[12:15], v[212:215], v[132:135], v[12:15]
    v_mfma_f32_16x16x32_bf16 v[36:39], v[212:215], v[136:139], v[36:39]
    v_mfma_f32_16x16x32_bf16 v[44:47], v[212:215], v[140:143], v[44:47]
    v_mfma_f32_16x16x32_bf16 v[16:19], v[216:219], v[128:131], v[16:19]
    ds_read_b128 v[152:155], v178 offset:45056
    v_mfma_f32_16x16x32_bf16 v[24:27], v[216:219], v[132:135], v[24:27]
    v_mfma_f32_16x16x32_bf16 v[48:51], v[216:219], v[136:139], v[48:51]
    v_mfma_f32_16x16x32_bf16 v[56:59], v[216:219], v[140:143], v[56:59]
    v_mfma_f32_16x16x32_bf16 v[20:23], v[220:223], v[128:131], v[20:23]
    ds_read_b128 v[156:159], v179 offset:45056
    v_mfma_f32_16x16x32_bf16 v[28:31], v[220:223], v[132:135], v[28:31]
    v_mfma_f32_16x16x32_bf16 v[52:55], v[220:223], v[136:139], v[52:55]
    v_mfma_f32_16x16x32_bf16 v[60:63], v[220:223], v[140:143], v[60:63]
    s_waitcnt lgkmcnt(0)
    s_barrier
    v_mfma_f32_16x16x32_bf16 v[64:67], v[208:211], v[144:147], v[64:67]
    s_add_u32 m0, s62, 32768
    v_mfma_f32_16x16x32_bf16 v[72:75], v[208:211], v[148:151], v[72:75]
    v_mfma_f32_16x16x32_bf16 v[96:99], v[208:211], v[152:155], v[96:99]
    buffer_load_dwordx4 v241, s[48:51], s60 offen offset:0 lds
    v_mfma_f32_16x16x32_bf16 v[104:107], v[208:211], v[156:159], v[104:107]
    v_mfma_f32_16x16x32_bf16 v[68:71], v[212:215], v[144:147], v[68:71]
    v_mfma_f32_16x16x32_bf16 v[76:79], v[212:215], v[148:151], v[76:79]
    buffer_load_dwordx4 v241, s[48:51], s60 offen offset:1024 lds
    v_mfma_f32_16x16x32_bf16 v[100:103], v[212:215], v[152:155], v[100:103]
    v_mfma_f32_16x16x32_bf16 v[108:111], v[212:215], v[156:159], v[108:111]
    v_mfma_f32_16x16x32_bf16 v[80:83], v[216:219], v[144:147], v[80:83]
    buffer_load_dwordx4 v241, s[48:51], s60 offen offset:2048 lds
    v_mfma_f32_16x16x32_bf16 v[88:91], v[216:219], v[148:151], v[88:91]
    v_mfma_f32_16x16x32_bf16 v[112:115], v[216:219], v[152:155], v[112:115]
    buffer_load_dwordx4 v241, s[48:51], s60 offen offset:3072 lds
    v_mfma_f32_16x16x32_bf16 v[120:123], v[216:219], v[156:159], v[120:123]
    v_mfma_f32_16x16x32_bf16 v[84:87], v[220:223], v[144:147], v[84:87]
    v_mfma_f32_16x16x32_bf16 v[92:95], v[220:223], v[148:151], v[92:95]
    s_add_u32 s60, s60, 32768
    v_mfma_f32_16x16x32_bf16 v[116:119], v[220:223], v[152:155], v[116:119]
    v_mfma_f32_16x16x32_bf16 v[124:127], v[220:223], v[156:159], v[124:127]
    s_nop 7
    s_cmp_lt_u32 s66, 2
    s_cbranch_scc0 K2_GU
    s_mov_b32 s5, 0x3e0293ee
    s_lshl_b32 s3, s66, 12
    s_cmp_eq_u32 s65, 0
    s_mov_b32 s4, 131072
    s_cselect_b32 s4, 49152, s4
    s_mov_b32 s6, 16384
    s_cselect_b32 s6, 65536, s6
    s_add_u32 s3, s3, s4
    v_and_b32 v246, 15, v253
    v_lshlrev_b32 v246, 4, v246
    v_bfe_u32 v247, v253, 4, 1
    v_lshl_or_b32 v246, v247, 9, v246
    v_lshrrev_b32 v247, 5, v253
    v_lshl_or_b32 v246, v247, 10, v246
    v_add_u32 v246, s3, v246
    v_add_u32 v247, s6, v246
    v_mul_f32 v0, s5, v0
    v_mul_f32 v1, s5, v1
    v_mul_f32 v2, s5, v2
    v_mul_f32 v3, s5, v3
    v_mul_f32 v4, s5, v4
    v_mul_f32 v5, s5, v5
    v_mul_f32 v6, s5, v6
    v_mul_f32 v7, s5, v7
    v_cvt_pk_bf16_f32 v128, v0, v1
    v_cvt_pk_bf16_f32 v129, v2, v3
    v_cvt_pk_bf16_f32 v130, v4, v5
    v_cvt_pk_bf16_f32 v131, v6, v7
    ds_write_b128 v246, v[128:131] offset:0
    v_mul_f32 v8, s5, v8
    v_mul_f32 v9, s5, v9
    v_mul_f32 v10, s5, v10
    v_mul_f32 v11, s5, v11
    v_mul_f32 v12, s5, v12
    v_mul_f32 v13, s5, v13
    v_mul_f32 v14, s5, v14
    v_mul_f32 v15, s5, v15
    v_cvt_pk_bf16_f32 v132, v8, v9
    v_cvt_pk_bf16_f32 v133, v10, v11
    v_cvt_pk_bf16_f32 v134, v12, v13
    v_cvt_pk_bf16_f32 v135, v14, v15
    ds_write_b128 v246, v[132:135] offset:256
    v_mul_f32 v16, s5, v16
    v_mul_f32 v17, s5, v17
    v_mul_f32 v18, s5, v18
    v_mul_f32 v19, s5, v19
    v_mul_f32 v20, s5, v20
    v_mul_f32 v21, s5, v21
    v_mul_f32 v22, s5, v22
    v_mul_f32 v23, s5, v23
    v_cvt_pk_bf16_f32 v136, v16, v17
    v_cvt_pk_bf16_f32 v137, v18, v19
    v_cvt_pk_bf16_f32 v138, v20, v21
    v_cvt_pk_bf16_f32 v139, v22, v23
    ds_write_b128 v246, v[136:139] offset:2048
    v_mul_f32 v24, s5, v24
    v_mul_f32 v25, s5, v25
    v_mul_f32 v26, s5, v26
    v_mul_f32 v27, s5, v27
    v_mul_f32 v28, s5, v28
    v_mul_f32 v29, s5, v29
    v_mul_f32 v30, s5, v30
    v_mul_f32 v31, s5, v31
    v_cvt_pk_bf16_f32 v140, v24, v25
    v_cvt_pk_bf16_f32 v141, v26, v27
    v_cvt_pk_bf16_f32 v142, v28, v29
    v_cvt_pk_bf16_f32 v143, v30, v31
    ds_write_b128 v246, v[140:143] offset:2304
    v_mul_f32 v32, s5, v32
    v_mul_f32 v33, s5, v33
    v_mul_f32 v34, s5, v34
    v_mul_f32 v35, s5, v35
    v_mul_f32 v36, s5, v36
    v_mul_f32 v37, s5, v37
    v_mul_f32 v38, s5, v38
    v_mul_f32 v39, s5, v39
    v_cvt_pk_bf16_f32 v144, v32, v33
    v_cvt_pk_bf16_f32 v145, v34, v35
    v_cvt_pk_bf16_f32 v146, v36, v37
    v_cvt_pk_bf16_f32 v147, v38, v39
    ds_write_b128 v246, v[144:147] offset:8192
    v_mul_f32 v40, s5, v40
    v_mul_f32 v41, s5, v41
    v_mul_f32 v42, s5, v42
    v_mul_f32 v43, s5, v43
    v_mul_f32 v44, s5, v44
    v_mul_f32 v45, s5, v45
    v_mul_f32 v46, s5, v46
    v_mul_f32 v47, s5, v47
    v_cvt_pk_bf16_f32 v148, v40, v41
    v_cvt_pk_bf16_f32 v149, v42, v43
    v_cvt_pk_bf16_f32 v150, v44, v45
    v_cvt_pk_bf16_f32 v151, v46, v47
    ds_write_b128 v246, v[148:151] offset:8448
    v_mul_f32 v48, s5, v48
    v_mul_f32 v49, s5, v49
    v_mul_f32 v50, s5, v50
    v_mul_f32 v51, s5, v51
    v_mul_f32 v52, s5, v52
    v_mul_f32 v53, s5, v53
    v_mul_f32 v54, s5, v54
    v_mul_f32 v55, s5, v55
    v_cvt_pk_bf16_f32 v152, v48, v49
    v_cvt_pk_bf16_f32 v153, v50, v51
    v_cvt_pk_bf16_f32 v154, v52, v53
    v_cvt_pk_bf16_f32 v155, v54, v55
    ds_write_b128 v246, v[152:155] offset:10240
    v_mul_f32 v56, s5, v56
    v_mul_f32 v57, s5, v57
    v_mul_f32 v58, s5, v58
    v_mul_f32 v59, s5, v59
    v_mul_f32 v60, s5, v60
    v_mul_f32 v61, s5, v61
    v_mul_f32 v62, s5, v62
    v_mul_f32 v63, s5, v63
    v_cvt_pk_bf16_f32 v156, v56, v57
    v_cvt_pk_bf16_f32 v157, v58, v59
    v_cvt_pk_bf16_f32 v158, v60, v61
    v_cvt_pk_bf16_f32 v159, v62, v63
    ds_write_b128 v246, v[156:159] offset:10496
    v_mul_f32 v64, s5, v64
    v_mul_f32 v65, s5, v65
    v_mul_f32 v66, s5, v66
    v_mul_f32 v67, s5, v67
    v_mul_f32 v68, s5, v68
    v_mul_f32 v69, s5, v69
    v_mul_f32 v70, s5, v70
    v_mul_f32 v71, s5, v71
    v_cvt_pk_bf16_f32 v128, v64, v65
    v_cvt_pk_bf16_f32 v129, v66, v67
    v_cvt_pk_bf16_f32 v130, v68, v69
    v_cvt_pk_bf16_f32 v131, v70, v71
    ds_write_b128 v247, v[128:131] offset:0
    v_mul_f32 v72, s5, v72
    v_mul_f32 v73, s5, v73
    v_mul_f32 v74, s5, v74
    v_mul_f32 v75, s5, v75
    v_mul_f32 v76, s5, v76
    v_mul_f32 v77, s5, v77
    v_mul_f32 v78, s5, v78
    v_mul_f32 v79, s5, v79
    v_cvt_pk_bf16_f32 v132, v72, v73
    v_cvt_pk_bf16_f32 v133, v74, v75
    v_cvt_pk_bf16_f32 v134, v76, v77
    v_cvt_pk_bf16_f32 v135, v78, v79
    ds_write_b128 v247, v[132:135] offset:256
    v_mul_f32 v80, s5, v80
    v_mul_f32 v81, s5, v81
    v_mul_f32 v82, s5, v82
    v_mul_f32 v83, s5, v83
    v_mul_f32 v84, s5, v84
    v_mul_f32 v85, s5, v85
    v_mul_f32 v86, s5, v86
    v_mul_f32 v87, s5, v87
    v_cvt_pk_bf16_f32 v136, v80, v81
    v_cvt_pk_bf16_f32 v137, v82, v83
    v_cvt_pk_bf16_f32 v138, v84, v85
    v_cvt_pk_bf16_f32 v139, v86, v87
    ds_write_b128 v247, v[136:139] offset:2048
    v_mul_f32 v88, s5, v88
    v_mul_f32 v89, s5, v89
    v_mul_f32 v90, s5, v90
    v_mul_f32 v91, s5, v91
    v_mul_f32 v92, s5, v92
    v_mul_f32 v93, s5, v93
    v_mul_f32 v94, s5, v94
    v_mul_f32 v95, s5, v95
    v_cvt_pk_bf16_f32 v140, v88, v89
    v_cvt_pk_bf16_f32 v141, v90, v91
    v_cvt_pk_bf16_f32 v142, v92, v93
    v_cvt_pk_bf16_f32 v143, v94, v95
    ds_write_b128 v247, v[140:143] offset:2304
    v_mul_f32 v96, s5, v96
    v_mul_f32 v97, s5, v97
    v_mul_f32 v98, s5, v98
    v_mul_f32 v99, s5, v99
    v_mul_f32 v100, s5, v100
    v_mul_f32 v101, s5, v101
    v_mul_f32 v102, s5, v102
    v_mul_f32 v103, s5, v103
    v_cvt_pk_bf16_f32 v144, v96, v97
    v_cvt_pk_bf16_f32 v145, v98, v99
    v_cvt_pk_bf16_f32 v146, v100, v101
    v_cvt_pk_bf16_f32 v147, v102, v103
    ds_write_b128 v247, v[144:147] offset:8192
    v_mul_f32 v104, s5, v104
    v_mul_f32 v105, s5, v105
    v_mul_f32 v106, s5, v106
    v_mul_f32 v107, s5, v107
    v_mul_f32 v108, s5, v108
    v_mul_f32 v109, s5, v109
    v_mul_f32 v110, s5, v110
    v_mul_f32 v111, s5, v111
    v_cvt_pk_bf16_f32 v148, v104, v105
    v_cvt_pk_bf16_f32 v149, v106, v107
    v_cvt_pk_bf16_f32 v150, v108, v109
    v_cvt_pk_bf16_f32 v151, v110, v111
    ds_write_b128 v247, v[148:151] offset:8448
    v_mul_f32 v112, s5, v112
    v_mul_f32 v113, s5, v113
    v_mul_f32 v114, s5, v114
    v_mul_f32 v115, s5, v115
    v_mul_f32 v116, s5, v116
    v_mul_f32 v117, s5, v117
    v_mul_f32 v118, s5, v118
    v_mul_f32 v119, s5, v119
    v_cvt_pk_bf16_f32 v152, v112, v113
    v_cvt_pk_bf16_f32 v153, v114, v115
    v_cvt_pk_bf16_f32 v154, v116, v117
    v_cvt_pk_bf16_f32 v155, v118, v119
    ds_write_b128 v247, v[152:155] offset:10240
    v_mul_f32 v120, s5, v120
    v_mul_f32 v121, s5, v121
    v_mul_f32 v122, s5, v122
    v_mul_f32 v123, s5, v123
    v_mul_f32 v124, s5, v124
    v_mul_f32 v125, s5, v125
    v_mul_f32 v126, s5, v126
    v_mul_f32 v127, s5, v127
    v_cvt_pk_bf16_f32 v156, v120, v121
    v_cvt_pk_bf16_f32 v157, v122, v123
    v_cvt_pk_bf16_f32 v158, v124, v125
    v_cvt_pk_bf16_f32 v159, v126, v127
    ds_write_b128 v247, v[156:159] offset:10496
    s_branch K2_ATT
K2_GU:
    v_max_f32 v96, 0, v96
    v_mul_f32 v96, v96, v112
    v_max_f32 v97, 0, v97
    v_mul_f32 v97, v97, v113
    v_max_f32 v98, 0, v98
    v_mul_f32 v98, v98, v114
    v_max_f32 v99, 0, v99
    v_mul_f32 v99, v99, v115
    v_max_f32 v100, 0, v100
    v_mul_f32 v100, v100, v116
    v_max_f32 v101, 0, v101
    v_mul_f32 v101, v101, v117
    v_max_f32 v102, 0, v102
    v_mul_f32 v102, v102, v118
    v_max_f32 v103, 0, v103
    v_mul_f32 v103, v103, v119
    v_cvt_pk_bf16_f32 v96, v96, v97
    v_cvt_pk_bf16_f32 v97, v98, v99
    v_cvt_pk_bf16_f32 v98, v100, v101
    v_cvt_pk_bf16_f32 v99, v102, v103
    v_max_f32 v104, 0, v104
    v_mul_f32 v104, v104, v120
    v_max_f32 v105, 0, v105
    v_mul_f32 v105, v105, v121
    v_max_f32 v106, 0, v106
    v_mul_f32 v106, v106, v122
    v_max_f32 v107, 0, v107
    v_mul_f32 v107, v107, v123
    v_max_f32 v108, 0, v108
    v_mul_f32 v108, v108, v124
    v_max_f32 v109, 0, v109
    v_mul_f32 v109, v109, v125
    v_max_f32 v110, 0, v110
    v_mul_f32 v110, v110, v126
    v_max_f32 v111, 0, v111
    v_mul_f32 v111, v111, v127
    v_cvt_pk_bf16_f32 v100, v104, v105
    v_cvt_pk_bf16_f32 v101, v106, v107
    v_cvt_pk_bf16_f32 v102, v108, v109
    v_cvt_pk_bf16_f32 v103, v110, v111
    v_max_f32 v0, 0, v0
    v_mul_f32 v0, v0, v16
    v_max_f32 v1, 0, v1
    v_mul_f32 v1, v1, v17
    v_max_f32 v2, 0, v2
    v_mul_f32 v2, v2, v18
    v_max_f32 v3, 0, v3
    v_mul_f32 v3, v3, v19
    v_max_f32 v4, 0, v4
    v_mul_f32 v4, v4, v20
    v_max_f32 v5, 0, v5
    v_mul_f32 v5, v5, v21
    v_max_f32 v6, 0, v6
    v_mul_f32 v6, v6, v22
    v_max_f32 v7, 0, v7
    v_mul_f32 v7, v7, v23
    v_cvt_pk_bf16_f32 v104, v0, v1
    v_cvt_pk_bf16_f32 v105, v2, v3
    v_cvt_pk_bf16_f32 v106, v4, v5
    v_cvt_pk_bf16_f32 v107, v6, v7
    v_max_f32 v8, 0, v8
    v_mul_f32 v8, v8, v24
    v_max_f32 v9, 0, v9
    v_mul_f32 v9, v9, v25
    v_max_f32 v10, 0, v10
    v_mul_f32 v10, v10, v26
    v_max_f32 v11, 0, v11
    v_mul_f32 v11, v11, v27
    v_max_f32 v12, 0, v12
    v_mul_f32 v12, v12, v28
    v_max_f32 v13, 0, v13
    v_mul_f32 v13, v13, v29
    v_max_f32 v14, 0, v14
    v_mul_f32 v14, v14, v30
    v_max_f32 v15, 0, v15
    v_mul_f32 v15, v15, v31
    v_cvt_pk_bf16_f32 v108, v8, v9
    v_cvt_pk_bf16_f32 v109, v10, v11
    v_cvt_pk_bf16_f32 v110, v12, v13
    v_cvt_pk_bf16_f32 v111, v14, v15
    v_max_f32 v32, 0, v32
    v_mul_f32 v32, v32, v48
    v_max_f32 v33, 0, v33
    v_mul_f32 v33, v33, v49
    v_max_f32 v34, 0, v34
    v_mul_f32 v34, v34, v50
    v_max_f32 v35, 0, v35
    v_mul_f32 v35, v35, v51
    v_max_f32 v36, 0, v36
    v_mul_f32 v36, v36, v52
    v_max_f32 v37, 0, v37
    v_mul_f32 v37, v37, v53
    v_max_f32 v38, 0, v38
    v_mul_f32 v38, v38, v54
    v_max_f32 v39, 0, v39
    v_mul_f32 v39, v39, v55
    v_cvt_pk_bf16_f32 v112, v32, v33
    v_cvt_pk_bf16_f32 v113, v34, v35
    v_cvt_pk_bf16_f32 v114, v36, v37
    v_cvt_pk_bf16_f32 v115, v38, v39
    v_max_f32 v40, 0, v40
    v_mul_f32 v40, v40, v56
    v_max_f32 v41, 0, v41
    v_mul_f32 v41, v41, v57
    v_max_f32 v42, 0, v42
    v_mul_f32 v42, v42, v58
    v_max_f32 v43, 0, v43
    v_mul_f32 v43, v43, v59
    v_max_f32 v44, 0, v44
    v_mul_f32 v44, v44, v60
    v_max_f32 v45, 0, v45
    v_mul_f32 v45, v45, v61
    v_max_f32 v46, 0, v46
    v_mul_f32 v46, v46, v62
    v_max_f32 v47, 0, v47
    v_mul_f32 v47, v47, v63
    v_cvt_pk_bf16_f32 v116, v40, v41
    v_cvt_pk_bf16_f32 v117, v42, v43
    v_cvt_pk_bf16_f32 v118, v44, v45
    v_cvt_pk_bf16_f32 v119, v46, v47
    v_max_f32 v64, 0, v64
    v_mul_f32 v64, v64, v80
    v_max_f32 v65, 0, v65
    v_mul_f32 v65, v65, v81
    v_max_f32 v66, 0, v66
    v_mul_f32 v66, v66, v82
    v_max_f32 v67, 0, v67
    v_mul_f32 v67, v67, v83
    v_max_f32 v68, 0, v68
    v_mul_f32 v68, v68, v84
    v_max_f32 v69, 0, v69
    v_mul_f32 v69, v69, v85
    v_max_f32 v70, 0, v70
    v_mul_f32 v70, v70, v86
    v_max_f32 v71, 0, v71
    v_mul_f32 v71, v71, v87
    v_cvt_pk_bf16_f32 v120, v64, v65
    v_cvt_pk_bf16_f32 v121, v66, v67
    v_cvt_pk_bf16_f32 v122, v68, v69
    v_cvt_pk_bf16_f32 v123, v70, v71
    v_max_f32 v72, 0, v72
    v_mul_f32 v72, v72, v88
    v_max_f32 v73, 0, v73
    v_mul_f32 v73, v73, v89
    v_max_f32 v74, 0, v74
    v_mul_f32 v74, v74, v90
    v_max_f32 v75, 0, v75
    v_mul_f32 v75, v75, v91
    v_max_f32 v76, 0, v76
    v_mul_f32 v76, v76, v92
    v_max_f32 v77, 0, v77
    v_mul_f32 v77, v77, v93
    v_max_f32 v78, 0, v78
    v_mul_f32 v78, v78, v94
    v_max_f32 v79, 0, v79
    v_mul_f32 v79, v79, v95
    v_cvt_pk_bf16_f32 v124, v72, v73
    v_cvt_pk_bf16_f32 v125, v74, v75
    v_cvt_pk_bf16_f32 v126, v76, v77
    v_cvt_pk_bf16_f32 v127, v78, v79
    s_mov_b32 s4, 0xffff0000
    s_mov_b32 s5, s4
    s_mov_b64 exec, s[4:5]
    v_swap_b32 v96, v98
    v_swap_b32 v97, v99
    v_swap_b32 v100, v102
    v_swap_b32 v101, v103
    v_swap_b32 v104, v106
    v_swap_b32 v105, v107
    v_swap_b32 v108, v110
    v_swap_b32 v109, v111
    v_swap_b32 v112, v114
    v_swap_b32 v113, v115
    v_swap_b32 v116, v118
    v_swap_b32 v117, v119
    v_swap_b32 v120, v122
    v_swap_b32 v121, v123
    v_swap_b32 v124, v126
    v_swap_b32 v125, v127
    s_mov_b64 exec, -1
K2_ATT:
    s_waitcnt vmcnt(4) lgkmcnt(0)
    s_barrier
    s_lshr_b32 s3, s66, 1
    s_lshl_b32 s3, s3, 16
    s_and_b32 s4, s66, 1
    s_lshl_b32 s4, s4, 13
    s_add_u32 s3, s3, s4
    s_add_u32 s3, s3, 49152
    v_lshl_add_u32 v246, v253, 4, s3
    ds_read_b128 v[144:147], v246 offset:0
    ds_read_b128 v[148:151], v246 offset:1024
    ds_read_b128 v[152:155], v246 offset:2048
    ds_read_b128 v[156:159], v246 offset:3072
    ds_read_b128 v[160:163], v246 offset:4096
    ds_read_b128 v[164:167], v246 offset:5120
    ds_read_b128 v[168:171], v246 offset:6144
    ds_read_b128 v[172:175], v246 offset:7168
    ds_read_b128 v[192:195], v240 offset:0
    ds_read_b128 v[196:199], v240 offset:1024
    ds_read_b128 v[200:203], v240 offset:2048
    ds_read_b128 v[204:207], v240 offset:3072
    ds_read_b128 v[208:211], v240 offset:4096
    ds_read_b128 v[212:215], v240 offset:5120
    s_cmp_lt_u32 s66, 2
    s_cbranch_scc1 K2_NOH
    s_cmp_ge_u32 s22, 27
    s_cbranch_scc1 K2_NOH
    s_cmp_eq_u32 s65, 0
    s_cselect_b32 s3, s57, s23
    s_mul_i32 s3, s3, 1456
    s_lshl_b32 s4, s22, 1
    s_add_u32 s3, s3, s4
    s_and_b32 s4, s66, 1
    s_add_u32 s3, s3, s4
    s_add_u32 s3, s3, 128
    s_lshl_b32 s3, s3, 10
    v_lshlrev_b32 v247, 4, v253
    buffer_store_dwordx4 v[104:107], v247, s[52:55], s3 offen sc1
    s_add_u32 s3, s3, 186368
    buffer_store_dwordx4 v[108:111], v247, s[52:55], s3 offen sc1
    s_add_u32 s3, s3, 186368
    buffer_store_dwordx4 v[112:115], v247, s[52:55], s3 offen sc1
    s_add_u32 s3, s3, 186368
    buffer_store_dwordx4 v[116:119], v247, s[52:55], s3 offen sc1
    s_add_u32 s3, s3, 186368
    buffer_store_dwordx4 v[120:123], v247, s[52:55], s3 offen sc1
    s_add_u32 s3, s3, 186368
    buffer_store_dwordx4 v[124:127], v247, s[52:55], s3 offen sc1
    s_add_u32 s3, s3, 186368
    buffer_store_dwordx4 v[96:99], v247, s[52:55], s3 offen sc1
    s_add_u32 s3, s3, 186368
    buffer_store_dwordx4 v[100:103], v247, s[52:55], s3 offen sc1
    s_add_u32 s3, s3, 186368
K2_NOH:
    v_mov_b64 v[0:1], 0
    v_mov_b64 v[2:3], 0
    v_mov_b64 v[4:5], 0
    v_mov_b64 v[6:7], 0
    v_mov_b64 v[8:9], 0
    v_mov_b64 v[10:11], 0
    v_mov_b64 v[12:13], 0
    v_mov_b64 v[14:15], 0
    v_mov_b64 v[16:17], 0
    v_mov_b64 v[18:19], 0
    v_mov_b64 v[20:21], 0
    v_mov_b64 v[22:23], 0
    v_mov_b64 v[24:25], 0
    v_mov_b64 v[26:27], 0
    v_mov_b64 v[28:29], 0
    v_mov_b64 v[30:31], 0
    v_mov_b64 v[32:33], 0
    v_mov_b64 v[34:35], 0
    v_mov_b64 v[36:37], 0
    v_mov_b64 v[38:39], 0
    v_mov_b64 v[40:41], 0
    v_mov_b64 v[42:43], 0
    v_mov_b64 v[44:45], 0
    v_mov_b64 v[46:47], 0
    v_mov_b64 v[48:49], 0
    v_mov_b64 v[50:51], 0
    v_mov_b64 v[52:53], 0
    v_mov_b64 v[54:55], 0
    v_mov_b64 v[56:57], 0
    v_mov_b64 v[58:59], 0
    v_mov_b64 v[60:61], 0
    v_mov_b64 v[62:63], 0
    v_mov_b64 v[128:129], 0
    v_mov_b64 v[130:131], 0
    v_mov_b64 v[132:133], 0
    v_mov_b64 v[134:135], 0
    v_mov_b64 v[136:137], 0
    v_mov_b64 v[138:139], 0
    v_mov_b64 v[140:141], 0
    v_mov_b64 v[142:143], 0
    v_mov_b32 v224, 0x3f803f80
    v_mov_b32 v225, 0x3f803f80
    v_mov_b32 v226, 0x3f803f80
    v_mov_b32 v227, 0x3f803f80
    v_mov_b64 v[228:229], 0
    v_mov_b64 v[230:231], 0
    v_mov_b64 v[232:233], 0
    v_mov_b64 v[234:235], 0
    s_waitcnt lgkmcnt(5)
    v_mfma_f32_32x32x16_bf16 v[64:79], v[192:195], v[144:147], v[128:143]
    ds_read_b128 v[216:219], v240 offset:6144
    s_waitcnt lgkmcnt(5)
    v_mfma_f32_32x32x16_bf16 v[64:79], v[196:199], v[148:151], v[64:79]
    ds_read_b128 v[220:223], v240 offset:7168
    s_waitcnt lgkmcnt(5)
    v_mfma_f32_32x32x16_bf16 v[64:79], v[200:203], v[152:155], v[64:79]
    ds_read_b128 v[192:195], v240 offset:8192
    s_waitcnt lgkmcnt(5)
    v_mfma_f32_32x32x16_bf16 v[64:79], v[204:207], v[156:159], v[64:79]
    ds_read_b128 v[196:199], v240 offset:9216
    s_waitcnt lgkmcnt(5)
    v_mfma_f32_32x32x16_bf16 v[64:79], v[208:211], v[160:163], v[64:79]
    ds_read_b128 v[200:203], v240 offset:10240
    s_waitcnt lgkmcnt(5)
    v_mfma_f32_32x32x16_bf16 v[64:79], v[212:215], v[164:167], v[64:79]
    ds_read_b128 v[204:207], v240 offset:11264
    s_waitcnt lgkmcnt(5)
    v_mfma_f32_32x32x16_bf16 v[64:79], v[216:219], v[168:171], v[64:79]
    ds_read_b128 v[208:211], v240 offset:12288
    s_waitcnt lgkmcnt(5)
    v_mfma_f32_32x32x16_bf16 v[64:79], v[220:223], v[172:175], v[64:79]
    ds_read_b128 v[212:215], v240 offset:13312
    s_waitcnt lgkmcnt(5)
    v_mfma_f32_32x32x16_bf16 v[80:95], v[192:195], v[144:147], v[128:143]
    ds_read_b128 v[216:219], v240 offset:14336
    s_waitcnt lgkmcnt(5)
    v_mfma_f32_32x32x16_bf16 v[80:95], v[196:199], v[148:151], v[80:95]
    ds_read_b128 v[220:223], v240 offset:15360
    s_waitcnt lgkmcnt(5)
    v_mfma_f32_32x32x16_bf16 v[80:95], v[200:203], v[152:155], v[80:95]
    s_waitcnt lgkmcnt(4)
    v_mfma_f32_32x32x16_bf16 v[80:95], v[204:207], v[156:159], v[80:95]
    s_waitcnt lgkmcnt(3)
    v_mfma_f32_32x32x16_bf16 v[80:95], v[208:211], v[160:163], v[80:95]
    s_waitcnt lgkmcnt(2)
    v_mfma_f32_32x32x16_bf16 v[80:95], v[212:215], v[164:167], v[80:95]
    s_waitcnt lgkmcnt(1)
    v_mfma_f32_32x32x16_bf16 v[80:95], v[216:219], v[168:171], v[80:95]
    s_waitcnt lgkmcnt(0)
    v_mfma_f32_32x32x16_bf16 v[80:95], v[220:223], v[172:175], v[80:95]
    s_barrier
    s_add_u32 m0, s62, 0
    s_nop 0
    buffer_load_dwordx4 v241, s[44:47], s59 offen offset:0 lds
    buffer_load_dwordx4 v241, s[44:47], s59 offen offset:1024 lds
    buffer_load_dwordx4 v241, s[44:47], s59 offen offset:2048 lds
    buffer_load_dwordx4 v241, s[44:47], s59 offen offset:3072 lds
    s_add_u32 s59, s59, 32768
    ds_read_b128 v[192:195], v240 offset:16384
    ds_read_b128 v[196:199], v240 offset:17408
    ds_read_b128 v[200:203], v240 offset:18432
    ds_read_b128 v[204:207], v240 offset:19456
    ds_read_b128 v[208:211], v240 offset:20480
    ds_read_b128 v[212:215], v240 offset:21504
    v_max3_f32 v254, v64, v65, v66
    v_max3_f32 v246, v80, v81, v82
    v_max3_f32 v254, v254, v67, v68
    v_max3_f32 v246, v246, v83, v84
    v_max3_f32 v254, v254, v69, v70
    v_max3_f32 v246, v246, v85, v86
    v_max3_f32 v254, v254, v71, v72
    v_max3_f32 v246, v246, v87, v88
    v_max3_f32 v254, v254, v73, v74
    v_max3_f32 v246, v246, v89, v90
    v_max3_f32 v254, v254, v75, v76
    v_max3_f32 v246, v246, v91, v92
    v_max3_f32 v254, v254, v77, v78
    v_max3_f32 v246, v246, v93, v94
    v_max3_f32 v254, v254, v79, v95
    v_max_f32 v254, v254, v246
    v_mov_b32 v246, v254
    s_nop 1
    v_permlane32_swap_b32 v254, v246
    v_max_f32 v254, v254, v246
    v_max_f32 v242, s68, v254
    v_sub_f32 v64, v64, v242
    v_sub_f32 v65, v65, v242
    v_sub_f32 v66, v66, v242
    v_sub_f32 v67, v67, v242
    v_sub_f32 v68, v68, v242
    v_sub_f32 v69, v69, v242
    v_sub_f32 v70, v70, v242
    v_sub_f32 v71, v71, v242
    v_sub_f32 v72, v72, v242
    v_sub_f32 v73, v73, v242
    v_sub_f32 v74, v74, v242
    v_sub_f32 v75, v75, v242
    v_sub_f32 v76, v76, v242
    v_sub_f32 v77, v77, v242
    v_sub_f32 v78, v78, v242
    v_sub_f32 v79, v79, v242
    v_sub_f32 v80, v80, v242
    v_sub_f32 v81, v81, v242
    v_sub_f32 v82, v82, v242
    v_sub_f32 v83, v83, v242
    v_sub_f32 v84, v84, v242
    v_sub_f32 v85, v85, v242
    v_sub_f32 v86, v86, v242
    v_sub_f32 v87, v87, v242
    v_sub_f32 v88, v88, v242
    v_sub_f32 v89, v89, v242
    v_sub_f32 v90, v90, v242
    v_sub_f32 v91, v91, v242
    v_sub_f32 v92, v92, v242
    v_sub_f32 v93, v93, v242
    v_sub_f32 v94, v94, v242
    v_sub_f32 v95, v95, v242
    v_sub_f32 v128, 0, v242
    v_sub_f32 v129, 0, v242
    v_sub_f32 v130, 0, v242
    v_sub_f32 v131, 0, v242
    v_sub_f32 v132, 0, v242
    v_sub_f32 v133, 0, v242
    v_sub_f32 v134, 0, v242
    v_sub_f32 v135, 0, v242
    v_sub_f32 v136, 0, v242
    v_sub_f32 v137, 0, v242
    v_sub_f32 v138, 0, v242
    v_sub_f32 v139, 0, v242
    v_sub_f32 v140, 0, v242
    v_sub_f32 v141, 0, v242
    v_sub_f32 v142, 0, v242
    v_sub_f32 v143, 0, v242
    s_nop 1
K2_LOOP:
    s_waitcnt lgkmcnt(3)
    v_mfma_f32_32x32x16_bf16 v[96:111], v[192:195], v[144:147], v[128:143]
    ds_read_b128 v[216:219], v240 offset:22528
    s_cmp_eq_u32 s56, s57
    s_cselect_b32 s60, s61, s60
    s_add_u32 m0, s62, 49152
    v_exp_f32 v64, v64
    v_exp_f32 v65, v65
    v_mfma_f32_32x32x16_bf16 v[96:111], v[196:199], v[148:151], v[96:111]
    ds_read_b128 v[220:223], v240 offset:23552
    v_exp_f32 v66, v66
    v_exp_f32 v67, v67
    v_cvt_pk_bf16_f32 v176, v64, v65
    buffer_load_dwordx4 v241, s[48:51], s60 offen offset:0 lds
    v_mfma_f32_32x32x16_bf16 v[96:111], v[200:203], v[152:155], v[96:111]
    ds_read_b128 v[192:195], v240 offset:24576
    v_exp_f32 v68, v68
    v_exp_f32 v69, v69
    s_waitcnt lgkmcnt(3)
    v_mfma_f32_32x32x16_bf16 v[96:111], v[204:207], v[156:159], v[96:111]
    ds_read_b128 v[196:199], v240 offset:25600
    v_cvt_pk_bf16_f32 v177, v66, v67
    v_exp_f32 v70, v70
    v_exp_f32 v71, v71
    buffer_load_dwordx4 v241, s[48:51], s60 offen offset:1024 lds
    v_mfma_f32_32x32x16_bf16 v[96:111], v[208:211], v[160:163], v[96:111]
    ds_read_b128 v[200:203], v240 offset:26624
    v_cvt_pk_bf16_f32 v178, v68, v69
    v_cvt_pk_bf16_f32 v179, v70, v71
    v_mfma_f32_32x32x16_bf16 v[96:111], v[212:215], v[164:167], v[96:111]
    ds_read_b128 v[204:207], v240 offset:27648
    v_exp_f32 v72, v72
    v_exp_f32 v73, v73
    v_exp_f32 v74, v74
    buffer_load_dwordx4 v241, s[48:51], s60 offen offset:2048 lds
    s_waitcnt lgkmcnt(3)
    v_mfma_f32_32x32x16_bf16 v[96:111], v[216:219], v[168:171], v[96:111]
    ds_read_b128 v[208:211], v240 offset:28672
    v_exp_f32 v75, v75
    v_cvt_pk_bf16_f32 v180, v72, v73
    v_mfma_f32_32x32x16_bf16 v[96:111], v[220:223], v[172:175], v[96:111]
    ds_read_b128 v[212:215], v240 offset:29696
    v_exp_f32 v76, v76
    v_exp_f32 v77, v77
    v_cvt_pk_bf16_f32 v181, v74, v75
    buffer_load_dwordx4 v241, s[48:51], s60 offen offset:3072 lds
    v_mfma_f32_32x32x16_bf16 v[112:127], v[192:195], v[144:147], v[128:143]
    ds_read_b128 v[216:219], v240 offset:30720
    v_exp_f32 v78, v78
    v_exp_f32 v79, v79
    s_add_u32 s60, s60, 32768
    s_add_u32 s3, s56, 2
    s_waitcnt lgkmcnt(3)
    v_mfma_f32_32x32x16_bf16 v[112:127], v[196:199], v[148:151], v[112:127]
    ds_read_b128 v[220:223], v240 offset:31744
    v_cvt_pk_bf16_f32 v182, v76, v77
    v_cvt_pk_bf16_f32 v183, v78, v79
    v_exp_f32 v80, v80
    s_cmp_eq_u32 s3, s57
    s_cselect_b32 s59, s61, s59
    v_mfma_f32_32x32x16_bf16 v[112:127], v[200:203], v[152:155], v[112:127]
    s_waitcnt vmcnt(8) lgkmcnt(0)
    s_barrier
    ds_read_b128 v[192:195], v240 offset:32768
    v_exp_f32 v81, v81
    v_exp_f32 v82, v82
    v_mfma_f32_32x32x16_bf16 v[112:127], v[204:207], v[156:159], v[112:127]
    ds_read_b128 v[196:199], v240 offset:33792
    v_permlane16_swap_b32 v176, v180
    v_permlane16_swap_b32 v177, v181
    v_permlane16_swap_b32 v178, v182
    s_cmp_ge_u32 s56, 14
    s_cselect_b32 s46, 0, s46
    s_add_u32 m0, s62, 16384
    v_mfma_f32_32x32x16_bf16 v[112:127], v[208:211], v[160:163], v[112:127]
    ds_read_b128 v[200:203], v240 offset:34816
    v_permlane16_swap_b32 v179, v183
    v_exp_f32 v83, v83
    buffer_load_dwordx4 v241, s[44:47], s59 offen offset:0 lds
    v_mfma_f32_32x32x16_bf16 v[112:127], v[212:215], v[164:167], v[112:127]
    ds_read_b128 v[204:207], v240 offset:35840
    v_cvt_pk_bf16_f32 v184, v80, v81
    v_exp_f32 v84, v84
    v_exp_f32 v85, v85
    v_mfma_f32_32x32x16_bf16 v[112:127], v[216:219], v[168:171], v[112:127]
    ds_read_b128 v[208:211], v240 offset:36864
    v_cvt_pk_bf16_f32 v185, v82, v83
    v_exp_f32 v86, v86
    v_mfma_f32_32x32x16_bf16 v[112:127], v[220:223], v[172:175], v[112:127]
    ds_read_b128 v[212:215], v240 offset:37888
    v_exp_f32 v87, v87
    v_cvt_pk_bf16_f32 v186, v84, v85
    v_cvt_pk_bf16_f32 v187, v86, v87
    buffer_load_dwordx4 v241, s[44:47], s59 offen offset:1024 lds
    s_waitcnt lgkmcnt(3)
    v_mfma_f32_16x16x32_bf16 v[0:3], v[192:195], v[176:179], v[0:3]
    ds_read_b128 v[216:219], v240 offset:38912
    v_exp_f32 v88, v88
    v_exp_f32 v89, v89
    v_mfma_f32_16x16x32_bf16 v[8:11], v[192:195], v[180:183], v[8:11]
    v_exp_f32 v90, v90
    v_mfma_f32_16x16x32_bf16 v[4:7], v[196:199], v[176:179], v[4:7]
    ds_read_b128 v[220:223], v240 offset:39936
    v_exp_f32 v91, v91
    v_cvt_pk_bf16_f32 v188, v88, v89
    v_mfma_f32_16x16x32_bf16 v[12:15], v[196:199], v[180:183], v[12:15]
    v_exp_f32 v92, v92
    v_mfma_f32_16x16x32_bf16 v[16:19], v[200:203], v[176:179], v[16:19]
    ds_read_b128 v[192:195], v240 offset:40960
    v_exp_f32 v93, v93
    v_cvt_pk_bf16_f32 v189, v90, v91
    v_mfma_f32_16x16x32_bf16 v[24:27], v[200:203], v[180:183], v[24:27]
    v_exp_f32 v94, v94
    buffer_load_dwordx4 v241, s[44:47], s59 offen offset:2048 lds
    s_waitcnt lgkmcnt(3)
    v_mfma_f32_16x16x32_bf16 v[20:23], v[204:207], v[176:179], v[20:23]
    ds_read_b128 v[196:199], v240 offset:41984
    v_exp_f32 v95, v95
    v_cvt_pk_bf16_f32 v190, v92, v93
    v_mfma_f32_16x16x32_bf16 v[28:31], v[204:207], v[180:183], v[28:31]
    v_cvt_pk_bf16_f32 v191, v94, v95
    v_mfma_f32_16x16x32_bf16 v[32:35], v[208:211], v[176:179], v[32:35]
    ds_read_b128 v[200:203], v240 offset:43008
    v_permlane16_swap_b32 v184, v188
    v_mfma_f32_16x16x32_bf16 v[40:43], v[208:211], v[180:183], v[40:43]
    v_permlane16_swap_b32 v185, v189
    v_mfma_f32_16x16x32_bf16 v[228:231], v[224:227], v[176:179], v[228:231]
    v_mfma_f32_16x16x32_bf16 v[36:39], v[212:215], v[176:179], v[36:39]
    ds_read_b128 v[204:207], v240 offset:44032
    v_permlane16_swap_b32 v186, v190
    v_permlane16_swap_b32 v187, v191
    v_mfma_f32_16x16x32_bf16 v[44:47], v[212:215], v[180:183], v[44:47]
    buffer_load_dwordx4 v241, s[44:47], s59 offen offset:3072 lds
    v_mfma_f32_16x16x32_bf16 v[232:235], v[224:227], v[180:183], v[232:235]
    s_waitcnt lgkmcnt(3)
    v_mfma_f32_16x16x32_bf16 v[48:51], v[216:219], v[176:179], v[48:51]
    ds_read_b128 v[208:211], v240 offset:45056
    v_mfma_f32_16x16x32_bf16 v[56:59], v[216:219], v[180:183], v[56:59]
    s_add_u32 s59, s59, 32768
    s_add_u32 s3, s56, 1
    s_cmp_eq_u32 s3, s57
    s_cbranch_scc1 MASK0
MASK_RET0:
    v_mfma_f32_16x16x32_bf16 v[52:55], v[220:223], v[176:179], v[52:55]
    ds_read_b128 v[212:215], v240 offset:46080
    v_max3_f32 v254, v96, v97, v98
    v_mfma_f32_16x16x32_bf16 v[60:63], v[220:223], v[180:183], v[60:63]
    v_max3_f32 v246, v112, v113, v114
    v_mfma_f32_16x16x32_bf16 v[0:3], v[192:195], v[184:187], v[0:3]
    ds_read_b128 v[216:219], v240 offset:47104
    v_max3_f32 v254, v254, v99, v100
    v_mfma_f32_16x16x32_bf16 v[8:11], v[192:195], v[188:191], v[8:11]
    v_max3_f32 v246, v246, v115, v116
    v_mfma_f32_16x16x32_bf16 v[228:231], v[224:227], v[184:187], v[228:231]
    s_waitcnt lgkmcnt(3)
    v_mfma_f32_16x16x32_bf16 v[4:7], v[196:199], v[184:187], v[4:7]
    ds_read_b128 v[220:223], v240 offset:48128
    v_max3_f32 v254, v254, v101, v102
    v_mfma_f32_16x16x32_bf16 v[12:15], v[196:199], v[188:191], v[12:15]
    v_max3_f32 v246, v246, v117, v118
    v_mfma_f32_16x16x32_bf16 v[232:235], v[224:227], v[188:191], v[232:235]
    v_mfma_f32_16x16x32_bf16 v[16:19], v[200:203], v[184:187], v[16:19]
    s_waitcnt vmcnt(8) lgkmcnt(0)
    s_barrier
    ds_read_b128 v[192:195], v240 offset:0
    v_max3_f32 v254, v254, v103, v104
    v_mfma_f32_16x16x32_bf16 v[24:27], v[200:203], v[188:191], v[24:27]
    v_max3_f32 v246, v246, v119, v120
    v_mfma_f32_16x16x32_bf16 v[20:23], v[204:207], v[184:187], v[20:23]
    ds_read_b128 v[196:199], v240 offset:1024
    v_max3_f32 v254, v254, v105, v106
    v_mfma_f32_16x16x32_bf16 v[28:31], v[204:207], v[188:191], v[28:31]
    v_max3_f32 v246, v246, v121, v122
    v_mfma_f32_16x16x32_bf16 v[32:35], v[208:211], v[184:187], v[32:35]
    ds_read_b128 v[200:203], v240 offset:2048
    v_max3_f32 v254, v254, v107, v108
    v_mfma_f32_16x16x32_bf16 v[40:43], v[208:211], v[188:191], v[40:43]
    v_max3_f32 v246, v246, v123, v124
    v_mfma_f32_16x16x32_bf16 v[36:39], v[212:215], v[184:187], v[36:39]
    ds_read_b128 v[204:207], v240 offset:3072
    v_max3_f32 v254, v254, v109, v110
    v_mfma_f32_16x16x32_bf16 v[44:47], v[212:215], v[188:191], v[44:47]
    v_max3_f32 v246, v246, v125, v126
    v_mfma_f32_16x16x32_bf16 v[48:51], v[216:219], v[184:187], v[48:51]
    ds_read_b128 v[208:211], v240 offset:4096
    v_max3_f32 v254, v254, v111, v127
    v_mfma_f32_16x16x32_bf16 v[56:59], v[216:219], v[188:191], v[56:59]
    v_max_f32 v254, v254, v246
    v_mfma_f32_16x16x32_bf16 v[52:55], v[220:223], v[184:187], v[52:55]
    ds_read_b128 v[212:215], v240 offset:5120
    v_cmp_lt_f32 vcc, s64, v254
    v_mfma_f32_16x16x32_bf16 v[60:63], v[220:223], v[188:191], v[60:63]
    s_cmp_eq_u32 s56, s57
    s_cbranch_scc1 BOUND0
    s_cbranch_vccnz RESC0
IT_RET0:
    s_add_u32 s56, s56, 1
    s_cmp_eq_u32 s56, s57
    s_cbranch_scc1 QSWAP0
QSWAP_RET0:
    s_waitcnt lgkmcnt(3)
    v_mfma_f32_32x32x16_bf16 v[64:79], v[192:195], v[144:147], v[128:143]
    ds_read_b128 v[216:219], v240 offset:6144
    s_cmp_eq_u32 s56, s57
    s_cselect_b32 s60, s61, s60
    s_add_u32 m0, s62, 32768
    v_exp_f32 v96, v96
    v_exp_f32 v97, v97
    v_mfma_f32_32x32x16_bf16 v[64:79], v[196:199], v[148:151], v[64:79]
    ds_read_b128 v[220:223], v240 offset:7168
    v_exp_f32 v98, v98
    v_exp_f32 v99, v99
    v_cvt_pk_bf16_f32 v176, v96, v97
    buffer_load_dwordx4 v241, s[48:51], s60 offen offset:0 lds
    v_mfma_f32_32x32x16_bf16 v[64:79], v[200:203], v[152:155], v[64:79]
    ds_read_b128 v[192:195], v240 offset:8192
    v_exp_f32 v100, v100
    v_exp_f32 v101, v101
    s_waitcnt lgkmcnt(3)
    v_mfma_f32_32x32x16_bf16 v[64:79], v[204:207], v[156:159], v[64:79]
    ds_read_b128 v[196:199], v240 offset:9216
    v_cvt_pk_bf16_f32 v177, v98, v99
    v_exp_f32 v102, v102
    v_exp_f32 v103, v103
    buffer_load_dwordx4 v241, s[48:51], s60 offen offset:1024 lds
    v_mfma_f32_32x32x16_bf16 v[64:79], v[208:211], v[160:163], v[64:79]
    ds_read_b128 v[200:203], v240 offset:10240
    v_cvt_pk_bf16_f32 v178, v100, v101
    v_cvt_pk_bf16_f32 v179, v102, v103
    v_mfma_f32_32x32x16_bf16 v[64:79], v[212:215], v[164:167], v[64:79]
    ds_read_b128 v[204:207], v240 offset:11264
    v_exp_f32 v104, v104
    v_exp_f32 v105, v105
    v_exp_f32 v106, v106
    buffer_load_dwordx4 v241, s[48:51], s60 offen offset:2048 lds
    s_waitcnt lgkmcnt(3)
    v_mfma_f32_32x32x16_bf16 v[64:79], v[216:219], v[168:171], v[64:79]
    ds_read_b128 v[208:211], v240 offset:12288
    v_exp_f32 v107, v107
    v_cvt_pk_bf16_f32 v180, v104, v105
    v_mfma_f32_32x32x16_bf16 v[64:79], v[220:223], v[172:175], v[64:79]
    ds_read_b128 v[212:215], v240 offset:13312
    v_exp_f32 v108, v108
    v_exp_f32 v109, v109
    v_cvt_pk_bf16_f32 v181, v106, v107
    buffer_load_dwordx4 v241, s[48:51], s60 offen offset:3072 lds
    v_mfma_f32_32x32x16_bf16 v[80:95], v[192:195], v[144:147], v[128:143]
    ds_read_b128 v[216:219], v240 offset:14336
    v_exp_f32 v110, v110
    v_exp_f32 v111, v111
    s_add_u32 s60, s60, 32768
    s_add_u32 s3, s56, 2
    s_waitcnt lgkmcnt(3)
    v_mfma_f32_32x32x16_bf16 v[80:95], v[196:199], v[148:151], v[80:95]
    ds_read_b128 v[220:223], v240 offset:15360
    v_cvt_pk_bf16_f32 v182, v108, v109
    v_cvt_pk_bf16_f32 v183, v110, v111
    v_exp_f32 v112, v112
    s_cmp_eq_u32 s3, s57
    s_cselect_b32 s59, s61, s59
    v_mfma_f32_32x32x16_bf16 v[80:95], v[200:203], v[152:155], v[80:95]
    s_waitcnt vmcnt(8) lgkmcnt(0)
    s_barrier
    ds_read_b128 v[192:195], v240 offset:49152
    v_exp_f32 v113, v113
    v_exp_f32 v114, v114
    v_mfma_f32_32x32x16_bf16 v[80:95], v[204:207], v[156:159], v[80:95]
    ds_read_b128 v[196:199], v240 offset:50176
    v_permlane16_swap_b32 v176, v180
    v_permlane16_swap_b32 v177, v181
    v_permlane16_swap_b32 v178, v182
    s_cmp_ge_u32 s56, 14
    s_cselect_b32 s46, 0, s46
    s_add_u32 m0, s62, 0
    v_mfma_f32_32x32x16_bf16 v[80:95], v[208:211], v[160:163], v[80:95]
    ds_read_b128 v[200:203], v240 offset:51200
    v_permlane16_swap_b32 v179, v183
    v_exp_f32 v115, v115
    buffer_load_dwordx4 v241, s[44:47], s59 offen offset:0 lds
    v_mfma_f32_32x32x16_bf16 v[80:95], v[212:215], v[164:167], v[80:95]
    ds_read_b128 v[204:207], v240 offset:52224
    v_cvt_pk_bf16_f32 v184, v112, v113
    v_exp_f32 v116, v116
    v_exp_f32 v117, v117
    v_mfma_f32_32x32x16_bf16 v[80:95], v[216:219], v[168:171], v[80:95]
    ds_read_b128 v[208:211], v240 offset:53248
    v_cvt_pk_bf16_f32 v185, v114, v115
    v_exp_f32 v118, v118
    v_mfma_f32_32x32x16_bf16 v[80:95], v[220:223], v[172:175], v[80:95]
    ds_read_b128 v[212:215], v240 offset:54272
    v_exp_f32 v119, v119
    v_cvt_pk_bf16_f32 v186, v116, v117
    v_cvt_pk_bf16_f32 v187, v118, v119
    buffer_load_dwordx4 v241, s[44:47], s59 offen offset:1024 lds
    s_waitcnt lgkmcnt(3)
    v_mfma_f32_16x16x32_bf16 v[0:3], v[192:195], v[176:179], v[0:3]
    ds_read_b128 v[216:219], v240 offset:55296
    v_exp_f32 v120, v120
    v_exp_f32 v121, v121
    v_mfma_f32_16x16x32_bf16 v[8:11], v[192:195], v[180:183], v[8:11]
    v_exp_f32 v122, v122
    v_mfma_f32_16x16x32_bf16 v[4:7], v[196:199], v[176:179], v[4:7]
    ds_read_b128 v[220:223], v240 offset:56320
    v_exp_f32 v123, v123
    v_cvt_pk_bf16_f32 v188, v120, v121
    v_mfma_f32_16x16x32_bf16 v[12:15], v[196:199], v[180:183], v[12:15]
    v_exp_f32 v124, v124
    v_mfma_f32_16x16x32_bf16 v[16:19], v[200:203], v[176:179], v[16:19]
    ds_read_b128 v[192:195], v240 offset:57344
    v_exp_f32 v125, v125
    v_cvt_pk_bf16_f32 v189, v122, v123
    v_mfma_f32_16x16x32_bf16 v[24:27], v[200:203], v[180:183], v[24:27]
    v_exp_f32 v126, v126
    buffer_load_dwordx4 v241, s[44:47], s59 offen offset:2048 lds
    s_waitcnt lgkmcnt(3)
    v_mfma_f32_16x16x32_bf16 v[20:23], v[204:207], v[176:179], v[20:23]
    ds_read_b128 v[196:199], v240 offset:58368
    v_exp_f32 v127, v127
    v_cvt_pk_bf16_f32 v190, v124, v125
    v_mfma_f32_16x16x32_bf16 v[28:31], v[204:207], v[180:183], v[28:31]
    v_cvt_pk_bf16_f32 v191, v126, v127
    v_mfma_f32_16x16x32_bf16 v[32:35], v[208:211], v[176:179], v[32:35]
    ds_read_b128 v[200:203], v240 offset:59392
    v_permlane16_swap_b32 v184, v188
    v_mfma_f32_16x16x32_bf16 v[40:43], v[208:211], v[180:183], v[40:43]
    v_permlane16_swap_b32 v185, v189
    v_mfma_f32_16x16x32_bf16 v[228:231], v[224:227], v[176:179], v[228:231]
    v_mfma_f32_16x16x32_bf16 v[36:39], v[212:215], v[176:179], v[36:39]
    ds_read_b128 v[204:207], v240 offset:60416
    v_permlane16_swap_b32 v186, v190
    v_permlane16_swap_b32 v187, v191
    v_mfma_f32_16x16x32_bf16 v[44:47], v[212:215], v[180:183], v[44:47]
    buffer_load_dwordx4 v241, s[44:47], s59 offen offset:3072 lds
    v_mfma_f32_16x16x32_bf16 v[232:235], v[224:227], v[180:183], v[232:235]
    s_waitcnt lgkmcnt(3)
    v_mfma_f32_16x16x32_bf16 v[48:51], v[216:219], v[176:179], v[48:51]
    ds_read_b128 v[208:211], v240 offset:61440
    v_mfma_f32_16x16x32_bf16 v[56:59], v[216:219], v[180:183], v[56:59]
    s_add_u32 s59, s59, 32768
    s_add_u32 s3, s56, 1
    s_cmp_eq_u32 s3, s57
    s_cbranch_scc1 MASK1
    s_cmp_eq_u32 s56, 15
    s_cbranch_scc1 MASK1
MASK_RET1:
    v_mfma_f32_16x16x32_bf16 v[52:55], v[220:223], v[176:179], v[52:55]
    ds_read_b128 v[212:215], v240 offset:62464
    v_max3_f32 v254, v64, v65, v66
    v_mfma_f32_16x16x32_bf16 v[60:63], v[220:223], v[180:183], v[60:63]
    v_max3_f32 v246, v80, v81, v82
    v_mfma_f32_16x16x32_bf16 v[0:3], v[192:195], v[184:187], v[0:3]
    ds_read_b128 v[216:219], v240 offset:63488
    v_max3_f32 v254, v254, v67, v68
    v_mfma_f32_16x16x32_bf16 v[8:11], v[192:195], v[188:191], v[8:11]
    v_max3_f32 v246, v246, v83, v84
    v_mfma_f32_16x16x32_bf16 v[228:231], v[224:227], v[184:187], v[228:231]
    s_waitcnt lgkmcnt(3)
    v_mfma_f32_16x16x32_bf16 v[4:7], v[196:199], v[184:187], v[4:7]
    ds_read_b128 v[220:223], v240 offset:64512
    v_max3_f32 v254, v254, v69, v70
    v_mfma_f32_16x16x32_bf16 v[12:15], v[196:199], v[188:191], v[12:15]
    v_max3_f32 v246, v246, v85, v86
    v_mfma_f32_16x16x32_bf16 v[232:235], v[224:227], v[188:191], v[232:235]
    v_mfma_f32_16x16x32_bf16 v[16:19], v[200:203], v[184:187], v[16:19]
    s_waitcnt vmcnt(8) lgkmcnt(0)
    s_barrier
    ds_read_b128 v[192:195], v240 offset:16384
    v_max3_f32 v254, v254, v71, v72
    v_mfma_f32_16x16x32_bf16 v[24:27], v[200:203], v[188:191], v[24:27]
    v_max3_f32 v246, v246, v87, v88
    v_mfma_f32_16x16x32_bf16 v[20:23], v[204:207], v[184:187], v[20:23]
    ds_read_b128 v[196:199], v240 offset:17408
    v_max3_f32 v254, v254, v73, v74
    v_mfma_f32_16x16x32_bf16 v[28:31], v[204:207], v[188:191], v[28:31]
    v_max3_f32 v246, v246, v89, v90
    v_mfma_f32_16x16x32_bf16 v[32:35], v[208:211], v[184:187], v[32:35]
    ds_read_b128 v[200:203], v240 offset:18432
    v_max3_f32 v254, v254, v75, v76
    v_mfma_f32_16x16x32_bf16 v[40:43], v[208:211], v[188:191], v[40:43]
    v_max3_f32 v246, v246, v91, v92
    v_mfma_f32_16x16x32_bf16 v[36:39], v[212:215], v[184:187], v[36:39]
    ds_read_b128 v[204:207], v240 offset:19456
    v_max3_f32 v254, v254, v77, v78
    v_mfma_f32_16x16x32_bf16 v[44:47], v[212:215], v[188:191], v[44:47]
    v_max3_f32 v246, v246, v93, v94
    v_mfma_f32_16x16x32_bf16 v[48:51], v[216:219], v[184:187], v[48:51]
    ds_read_b128 v[208:211], v240 offset:20480
    v_max3_f32 v254, v254, v79, v95
    v_mfma_f32_16x16x32_bf16 v[56:59], v[216:219], v[188:191], v[56:59]
    v_max_f32 v254, v254, v246
    v_mfma_f32_16x16x32_bf16 v[52:55], v[220:223], v[184:187], v[52:55]
    ds_read_b128 v[212:215], v240 offset:21504
    v_cmp_lt_f32 vcc, s64, v254
    v_mfma_f32_16x16x32_bf16 v[60:63], v[220:223], v[188:191], v[60:63]
    s_cmp_eq_u32 s56, s57
    s_cbranch_scc1 BOUND1
    s_cbranch_vccnz RESC1
IT_RET1:
    s_add_u32 s56, s56, 1
    s_cmp_eq_u32 s56, s57
    s_cbranch_scc1 QSWAP1
QSWAP_RET1:
    s_cmp_lt_u32 s56, 16
    s_cbranch_scc1 K2_LOOP
    s_load_dwordx2 s[28:29], s[0:1], 40
    s_load_dwordx2 s[30:31], s[0:1], 72
    s_lshl_b32 s3, s23, 2
    s_and_b32 s4, s22, 3
    s_add_u32 s3, s3, s4
    s_lshl_b32 s3, s3, 3
    s_add_u32 s3, s3, s21
    s_min_u32 s3, s3, 229
    s_lshl_b32 s3, s3, 13
    s_lshr_b32 s4, s22, 3
    s_mul_i32 s4, s4, 1884160
    s_add_u32 s3, s3, s4
    v_lshlrev_b32 v127, 7, v253
    s_waitcnt vmcnt(0) lgkmcnt(0)
    s_barrier
    s_cmp_lt_u32 s3, 5242880
    s_cselect_b32 s6, s28, s30
    s_cselect_b32 s7, s29, s31
    s_mov_b32 s5, 2211840
    s_cselect_b32 s5, 5242880, s5
    s_mov_b32 s4, 5242880
    s_cselect_b32 s4, 0, s4
    s_mov_b32 s44, s6
    s_and_b32 s45, s7, 0xffff
    s_mov_b32 s46, s5
    s_mov_b32 s47, 0x20000
    s_sub_u32 s3, s3, s4
    buffer_load_dword v255, v127, s[44:47], s3 offen
    buffer_load_dword v255, v127, s[44:47], s3 offen offset:64
    ds_read_b128 v[192:195], v240 offset:32768
    ds_read_b128 v[196:199], v240 offset:33792
    ds_read_b128 v[200:203], v240 offset:34816
    ds_read_b128 v[204:207], v240 offset:35840
    ds_read_b128 v[208:211], v240 offset:36864
    ds_read_b128 v[212:215], v240 offset:37888
    v_exp_f32 v64, v64
    v_exp_f32 v65, v65
    v_exp_f32 v66, v66
    v_exp_f32 v67, v67
    v_cvt_pk_bf16_f32 v176, v64, v65
    v_exp_f32 v68, v68
    v_exp_f32 v69, v69
    v_cvt_pk_bf16_f32 v177, v66, v67
    v_exp_f32 v70, v70
    v_exp_f32 v71, v71
    v_cvt_pk_bf16_f32 v178, v68, v69
    v_cvt_pk_bf16_f32 v179, v70, v71
    v_exp_f32 v72, v72
    v_exp_f32 v73, v73
    v_exp_f32 v74, v74
    v_exp_f32 v75, v75
    v_cvt_pk_bf16_f32 v180, v72, v73
    v_exp_f32 v76, v76
    v_exp_f32 v77, v77
    v_cvt_pk_bf16_f32 v181, v74, v75
    v_exp_f32 v78, v78
    v_exp_f32 v79, v79
    v_cvt_pk_bf16_f32 v182, v76, v77
    v_cvt_pk_bf16_f32 v183, v78, v79
    s_nop 1
    v_permlane16_swap_b32 v176, v180
    v_permlane16_swap_b32 v177, v181
    v_permlane16_swap_b32 v178, v182
    v_permlane16_swap_b32 v179, v183
    s_nop 0
    s_waitcnt lgkmcnt(5)
    v_mfma_f32_16x16x32_bf16 v[0:3], v[192:195], v[176:179], v[0:3]
    v_mfma_f32_16x16x32_bf16 v[8:11], v[192:195], v[180:183], v[8:11]
    ds_read_b128 v[216:219], v240 offset:38912
    v_exp_f32 v80, v80
    v_exp_f32 v81, v81
    v_exp_f32 v82, v82
    v_exp_f32 v83, v83
    s_waitcnt lgkmcnt(5)
    v_mfma_f32_16x16x32_bf16 v[4:7], v[196:199], v[176:179], v[4:7]
    v_mfma_f32_16x16x32_bf16 v[12:15], v[196:199], v[180:183], v[12:15]
    ds_read_b128 v[220:223], v240 offset:39936
    v_cvt_pk_bf16_f32 v184, v80, v81
    v_exp_f32 v84, v84
    v_exp_f32 v85, v85
    v_cvt_pk_bf16_f32 v185, v82, v83
    s_waitcnt lgkmcnt(5)
    v_mfma_f32_16x16x32_bf16 v[16:19], v[200:203], v[176:179], v[16:19]
    v_mfma_f32_16x16x32_bf16 v[24:27], v[200:203], v[180:183], v[24:27]
    ds_read_b128 v[192:195], v240 offset:40960
    v_exp_f32 v86, v86
    v_exp_f32 v87, v87
    v_cvt_pk_bf16_f32 v186, v84, v85
    v_cvt_pk_bf16_f32 v187, v86, v87
    s_waitcnt lgkmcnt(5)
    v_mfma_f32_16x16x32_bf16 v[20:23], v[204:207], v[176:179], v[20:23]
    v_mfma_f32_16x16x32_bf16 v[28:31], v[204:207], v[180:183], v[28:31]
    ds_read_b128 v[196:199], v240 offset:41984
    v_exp_f32 v88, v88
    v_exp_f32 v89, v89
    v_exp_f32 v90, v90
    v_exp_f32 v91, v91
    s_waitcnt lgkmcnt(5)
    v_mfma_f32_16x16x32_bf16 v[32:35], v[208:211], v[176:179], v[32:35]
    v_mfma_f32_16x16x32_bf16 v[40:43], v[208:211], v[180:183], v[40:43]
    ds_read_b128 v[200:203], v240 offset:43008
    v_cvt_pk_bf16_f32 v188, v88, v89
    v_exp_f32 v92, v92
    v_exp_f32 v93, v93
    v_cvt_pk_bf16_f32 v189, v90, v91
    s_waitcnt lgkmcnt(5)
    v_mfma_f32_16x16x32_bf16 v[36:39], v[212:215], v[176:179], v[36:39]
    v_mfma_f32_16x16x32_bf16 v[44:47], v[212:215], v[180:183], v[44:47]
    ds_read_b128 v[204:207], v240 offset:44032
    v_exp_f32 v94, v94
    v_exp_f32 v95, v95
    v_cvt_pk_bf16_f32 v190, v92, v93
    v_cvt_pk_bf16_f32 v191, v94, v95
    s_waitcnt lgkmcnt(5)
    v_mfma_f32_16x16x32_bf16 v[48:51], v[216:219], v[176:179], v[48:51]
    v_mfma_f32_16x16x32_bf16 v[56:59], v[216:219], v[180:183], v[56:59]
    ds_read_b128 v[208:211], v240 offset:45056
    v_permlane16_swap_b32 v184, v188
    v_permlane16_swap_b32 v185, v189
    v_permlane16_swap_b32 v186, v190
    v_permlane16_swap_b32 v187, v191
    s_waitcnt lgkmcnt(5)
    v_mfma_f32_16x16x32_bf16 v[52:55], v[220:223], v[176:179], v[52:55]
    v_mfma_f32_16x16x32_bf16 v[60:63], v[220:223], v[180:183], v[60:63]
    ds_read_b128 v[212:215], v240 offset:46080
    v_mfma_f32_16x16x32_bf16 v[228:231], v[224:227], v[176:179], v[228:231]
    v_mfma_f32_16x16x32_bf16 v[232:235], v[224:227], v[180:183], v[232:235]
    s_waitcnt lgkmcnt(5)
    v_mfma_f32_16x16x32_bf16 v[0:3], v[192:195], v[184:187], v[0:3]
    v_mfma_f32_16x16x32_bf16 v[8:11], v[192:195], v[188:191], v[8:11]
    ds_read_b128 v[216:219], v240 offset:47104
    s_waitcnt lgkmcnt(5)
    v_mfma_f32_16x16x32_bf16 v[4:7], v[196:199], v[184:187], v[4:7]
    v_mfma_f32_16x16x32_bf16 v[12:15], v[196:199], v[188:191], v[12:15]
    ds_read_b128 v[220:223], v240 offset:48128
    v_mfma_f32_16x16x32_bf16 v[228:231], v[224:227], v[184:187], v[228:231]
    s_waitcnt lgkmcnt(5)
    v_mfma_f32_16x16x32_bf16 v[16:19], v[200:203], v[184:187], v[16:19]
    v_mfma_f32_16x16x32_bf16 v[24:27], v[200:203], v[188:191], v[24:27]
    s_waitcnt lgkmcnt(4)
    v_mfma_f32_16x16x32_bf16 v[20:23], v[204:207], v[184:187], v[20:23]
    v_mfma_f32_16x16x32_bf16 v[28:31], v[204:207], v[188:191], v[28:31]
    v_mfma_f32_16x16x32_bf16 v[232:235], v[224:227], v[188:191], v[232:235]
    s_waitcnt lgkmcnt(3)
    v_mfma_f32_16x16x32_bf16 v[32:35], v[208:211], v[184:187], v[32:35]
    v_mfma_f32_16x16x32_bf16 v[40:43], v[208:211], v[188:191], v[40:43]
    s_waitcnt lgkmcnt(2)
    v_mfma_f32_16x16x32_bf16 v[36:39], v[212:215], v[184:187], v[36:39]
    v_mfma_f32_16x16x32_bf16 v[44:47], v[212:215], v[188:191], v[44:47]
    s_waitcnt lgkmcnt(1)
    v_mfma_f32_16x16x32_bf16 v[48:51], v[216:219], v[184:187], v[48:51]
    v_mfma_f32_16x16x32_bf16 v[56:59], v[216:219], v[188:191], v[56:59]
    s_waitcnt lgkmcnt(0)
    v_mfma_f32_16x16x32_bf16 v[52:55], v[220:223], v[184:187], v[52:55]
    v_mfma_f32_16x16x32_bf16 v[60:63], v[220:223], v[188:191], v[60:63]
    s_barrier
    s_mov_b32 s63, 2
    s_and_b32 s3, s66, 1
    s_lshl_b32 s3, s3, 13
    s_cmp_lt_u32 s66, 2
    s_mov_b32 s4, 32768
    s_cselect_b32 s4, 131072, s4
    s_mov_b32 s5, 65536
    s_cselect_b32 s5, 16384, s5
    s_add_u32 s3, s3, s4
    s_mul_i32 s4, s5, s65
    s_add_u32 s3, s3, s4
    s_mov_b32 s6, 0xffff0000
    s_mov_b32 s7, s6
    v_cndmask_b32 v243, v228, v232, s[6:7]
    v_lshl_add_u32 v248, v253, 4, s3
    v_xor_b32 v249, s5, v248
    ds_write_b64 v249, v[242:243]
    s_waitcnt lgkmcnt(0)
    s_barrier
    ds_read_b64 v[250:251], v248
    s_cmp_eq_u32 s65, 0
    s_waitcnt lgkmcnt(0)
    s_cbranch_scc1 MERGE0
    s_branch MERGE1
QSWAP0:
    s_lshl_b32 s3, s66, 13
    s_add_u32 s3, s3, 131072
    v_lshl_add_u32 v246, v253, 4, s3
    ds_read_b128 v[144:147], v246 offset:0
    ds_read_b128 v[148:151], v246 offset:1024
    ds_read_b128 v[152:155], v246 offset:2048
    ds_read_b128 v[156:159], v246 offset:3072
    ds_read_b128 v[160:163], v246 offset:4096
    ds_read_b128 v[164:167], v246 offset:5120
    ds_read_b128 v[168:171], v246 offset:6144
    ds_read_b128 v[172:175], v246 offset:7168
    v_mov_b64 v[128:129], 0
    v_mov_b64 v[130:131], 0
    v_mov_b64 v[132:133], 0
    v_mov_b64 v[134:135], 0
    v_mov_b64 v[136:137], 0
    v_mov_b64 v[138:139], 0
    v_mov_b64 v[140:141], 0
    v_mov_b64 v[142:143], 0
    s_waitcnt lgkmcnt(0)
    s_branch QSWAP_RET0
MASK0:
    s_nop 7
    v_mov_b32 v247, 0xff800000
    v_cmp_gt_i32 s[70:71], 0, v245
    v_cmp_gt_i32 s[72:73], 1, v245
    v_cmp_gt_i32 s[74:75], 2, v245
    v_cmp_gt_i32 s[76:77], 3, v245
    s_nop 0
    v_cndmask_b32 v96, v96, v247, s[70:71]
    v_cndmask_b32 v97, v97, v247, s[72:73]
    v_cndmask_b32 v98, v98, v247, s[74:75]
    v_cndmask_b32 v99, v99, v247, s[76:77]
    v_cmp_gt_i32 s[70:71], 4, v245
    v_cmp_gt_i32 s[72:73], 5, v245
    v_cmp_gt_i32 s[74:75], 6, v245
    v_cmp_gt_i32 s[76:77], 7, v245
    s_nop 0
    v_cndmask_b32 v100, v100, v247, s[70:71]
    v_cndmask_b32 v101, v101, v247, s[72:73]
    v_cndmask_b32 v102, v102, v247, s[74:75]
    v_cndmask_b32 v103, v103, v247, s[76:77]
    v_cmp_gt_i32 s[70:71], 16, v245
    v_cmp_gt_i32 s[72:73], 17, v245
    v_cmp_gt_i32 s[74:75], 18, v245
    v_cmp_gt_i32 s[76:77], 19, v245
    s_nop 0
    v_cndmask_b32 v104, v104, v247, s[70:71]
    v_cndmask_b32 v105, v105, v247, s[72:73]
    v_cndmask_b32 v106, v106, v247, s[74:75]
    v_cndmask_b32 v107, v107, v247, s[76:77]
    v_cmp_gt_i32 s[70:71], 20, v245
    v_cmp_gt_i32 s[72:73], 21, v245
    v_cmp_gt_i32 s[74:75], 22, v245
    v_cmp_gt_i32 s[76:77], 23, v245
    s_nop 0
    v_cndmask_b32 v108, v108, v247, s[70:71]
    v_cndmask_b32 v109, v109, v247, s[72:73]
    v_cndmask_b32 v110, v110, v247, s[74:75]
    v_cndmask_b32 v111, v111, v247, s[76:77]
    v_cmp_gt_i32 s[70:71], 32, v245
    v_cmp_gt_i32 s[72:73], 33, v245
    v_cmp_gt_i32 s[74:75], 34, v245
    v_cmp_gt_i32 s[76:77], 35, v245
    s_nop 0
    v_cndmask_b32 v112, v112, v247, s[70:71]
    v_cndmask_b32 v113, v113, v247, s[72:73]
    v_cndmask_b32 v114, v114, v247, s[74:75]
    v_cndmask_b32 v115, v115, v247, s[76:77]
    v_cmp_gt_i32 s[70:71], 36, v245
    v_cmp_gt_i32 s[72:73], 37, v245
    v_cmp_gt_i32 s[74:75], 38, v245
    v_cmp_gt_i32 s[76:77], 39, v245
    s_nop 0
    v_cndmask_b32 v116, v116, v247, s[70:71]
    v_cndmask_b32 v117, v117, v247, s[72:73]
    v_cndmask_b32 v118, v118, v247, s[74:75]
    v_cndmask_b32 v119, v119, v247, s[76:77]
    v_cmp_gt_i32 s[70:71], 48, v245
    v_cmp_gt_i32 s[72:73], 49, v245
    v_cmp_gt_i32 s[74:75], 50, v245
    v_cmp_gt_i32 s[76:77], 51, v245
    s_nop 0
    v_cndmask_b32 v120, v120, v247, s[70:71]
    v_cndmask_b32 v121, v121, v247, s[72:73]
    v_cndmask_b32 v122, v122, v247, s[74:75]
    v_cndmask_b32 v123, v123, v247, s[76:77]
    v_cmp_gt_i32 s[70:71], 52, v245
    v_cmp_gt_i32 s[72:73], 53, v245
    v_cmp_gt_i32 s[74:75], 54, v245
    v_cmp_gt_i32 s[76:77], 55, v245
    s_nop 0
    v_cndmask_b32 v124, v124, v247, s[70:71]
    v_cndmask_b32 v125, v125, v247, s[72:73]
    v_cndmask_b32 v126, v126, v247, s[74:75]
    v_cndmask_b32 v127, v127, v247, s[76:77]
    s_branch MASK_RET0
RESC0:
    v_mov_b32 v246, v254
    s_nop 1
    v_permlane32_swap_b32 v254, v246
    v_max_f32 v254, v254, v246
    v_max_f32 v254, 0, v254
    v_add_f32 v242, v242, v254
    v_exp_f32 v246, -v254
    v_sub_f32 v96, v96, v254
    v_sub_f32 v97, v97, v254
    v_sub_f32 v98, v98, v254
    v_sub_f32 v99, v99, v254
    v_sub_f32 v100, v100, v254
    v_sub_f32 v101, v101, v254
    v_sub_f32 v102, v102, v254
    v_sub_f32 v103, v103, v254
    v_sub_f32 v104, v104, v254
    v_sub_f32 v105, v105, v254
    v_sub_f32 v106, v106, v254
    v_sub_f32 v107, v107, v254
    v_sub_f32 v108, v108, v254
    v_sub_f32 v109, v109, v254
    v_sub_f32 v110, v110, v254
    v_sub_f32 v111, v111, v254
    v_sub_f32 v112, v112, v254
    v_sub_f32 v113, v113, v254
    v_sub_f32 v114, v114, v254
    v_sub_f32 v115, v115, v254
    v_sub_f32 v116, v116, v254
    v_sub_f32 v117, v117, v254
    v_sub_f32 v118, v118, v254
    v_sub_f32 v119, v119, v254
    v_sub_f32 v120, v120, v254
    v_sub_f32 v121, v121, v254
    v_sub_f32 v122, v122, v254
    v_sub_f32 v123, v123, v254
    v_sub_f32 v124, v124, v254
    v_sub_f32 v125, v125, v254
    v_sub_f32 v126, v126, v254
    v_sub_f32 v127, v127, v254
    v_sub_f32 v128, 0, v242
    v_sub_f32 v129, 0, v242
    v_sub_f32 v130, 0, v242
    v_sub_f32 v131, 0, v242
    v_sub_f32 v132, 0, v242
    v_sub_f32 v133, 0, v242
    v_sub_f32 v134, 0, v242
    v_sub_f32 v135, 0, v242
    v_sub_f32 v136, 0, v242
    v_sub_f32 v137, 0, v242
    v_sub_f32 v138, 0, v242
    v_sub_f32 v139, 0, v242
    v_sub_f32 v140, 0, v242
    v_sub_f32 v141, 0, v242
    v_sub_f32 v142, 0, v242
    v_sub_f32 v143, 0, v242
    v_mov_b32 v247, v246
    s_nop 1
    v_permlane16_swap_b32 v246, v247
    v_mul_f32 v228, v228, v246
    v_mul_f32 v229, v229, v246
    v_mul_f32 v230, v230, v246
    v_mul_f32 v231, v231, v246
    v_mul_f32 v232, v232, v247
    v_mul_f32 v233, v233, v247
    v_mul_f32 v234, v234, v247
    v_mul_f32 v235, v235, v247
    v_mul_f32 v0, v0, v246
    v_mul_f32 v1, v1, v246
    v_mul_f32 v2, v2, v246
    v_mul_f32 v3, v3, v246
    v_mul_f32 v4, v4, v246
    v_mul_f32 v5, v5, v246
    v_mul_f32 v6, v6, v246
    v_mul_f32 v7, v7, v246
    v_mul_f32 v8, v8, v247
    v_mul_f32 v9, v9, v247
    v_mul_f32 v10, v10, v247
    v_mul_f32 v11, v11, v247
    v_mul_f32 v12, v12, v247
    v_mul_f32 v13, v13, v247
    v_mul_f32 v14, v14, v247
    v_mul_f32 v15, v15, v247
    v_mul_f32 v16, v16, v246
    v_mul_f32 v17, v17, v246
    v_mul_f32 v18, v18, v246
    v_mul_f32 v19, v19, v246
    v_mul_f32 v20, v20, v246
    v_mul_f32 v21, v21, v246
    v_mul_f32 v22, v22, v246
    v_mul_f32 v23, v23, v246
    v_mul_f32 v24, v24, v247
    v_mul_f32 v25, v25, v247
    v_mul_f32 v26, v26, v247
    v_mul_f32 v27, v27, v247
    v_mul_f32 v28, v28, v247
    v_mul_f32 v29, v29, v247
    v_mul_f32 v30, v30, v247
    v_mul_f32 v31, v31, v247
    v_mul_f32 v32, v32, v246
    v_mul_f32 v33, v33, v246
    v_mul_f32 v34, v34, v246
    v_mul_f32 v35, v35, v246
    v_mul_f32 v36, v36, v246
    v_mul_f32 v37, v37, v246
    v_mul_f32 v38, v38, v246
    v_mul_f32 v39, v39, v246
    v_mul_f32 v40, v40, v247
    v_mul_f32 v41, v41, v247
    v_mul_f32 v42, v42, v247
    v_mul_f32 v43, v43, v247
    v_mul_f32 v44, v44, v247
    v_mul_f32 v45, v45, v247
    v_mul_f32 v46, v46, v247
    v_mul_f32 v47, v47, v247
    v_mul_f32 v48, v48, v246
    v_mul_f32 v49, v49, v246
    v_mul_f32 v50, v50, v246
    v_mul_f32 v51, v51, v246
    v_mul_f32 v52, v52, v246
    v_mul_f32 v53, v53, v246
    v_mul_f32 v54, v54, v246
    v_mul_f32 v55, v55, v246
    v_mul_f32 v56, v56, v247
    v_mul_f32 v57, v57, v247
    v_mul_f32 v58, v58, v247
    v_mul_f32 v59, v59, v247
    v_mul_f32 v60, v60, v247
    v_mul_f32 v61, v61, v247
    v_mul_f32 v62, v62, v247
    v_mul_f32 v63, v63, v247
    s_branch IT_RET0
BOUND0:
    s_mov_b32 s63, 0
    s_and_b32 s3, s66, 1
    s_lshl_b32 s3, s3, 13
    s_cmp_lt_u32 s66, 2
    s_mov_b32 s4, 32768
    s_cselect_b32 s4, 131072, s4
    s_mov_b32 s5, 65536
    s_cselect_b32 s5, 16384, s5
    s_add_u32 s3, s3, s4
    s_mul_i32 s4, s5, s65
    s_add_u32 s3, s3, s4
    s_mov_b32 s6, 0xffff0000
    s_mov_b32 s7, s6
    v_cndmask_b32 v243, v228, v232, s[6:7]
    v_lshl_add_u32 v248, v253, 4, s3
    v_xor_b32 v249, s5, v248
    ds_write_b64 v249, v[242:243]
    s_waitcnt lgkmcnt(0)
    s_barrier
    ds_read_b64 v[250:251], v248
    s_cmp_eq_u32 s65, 0
    s_waitcnt lgkmcnt(0)
    s_cbranch_scc1 MERGE0
    s_branch MERGE1
BOUND_RET0:
    v_mov_b64 v[0:1], 0
    v_mov_b64 v[2:3], 0
    v_mov_b64 v[4:5], 0
    v_mov_b64 v[6:7], 0
    v_mov_b64 v[8:9], 0
    v_mov_b64 v[10:11], 0
    v_mov_b64 v[12:13], 0
    v_mov_b64 v[14:15], 0
    v_mov_b64 v[16:17], 0
    v_mov_b64 v[18:19], 0
    v_mov_b64 v[20:21], 0
    v_mov_b64 v[22:23], 0
    v_mov_b64 v[24:25], 0
    v_mov_b64 v[26:27], 0
    v_mov_b64 v[28:29], 0
    v_mov_b64 v[30:31], 0
    v_mov_b64 v[32:33], 0
    v_mov_b64 v[34:35], 0
    v_mov_b64 v[36:37], 0
    v_mov_b64 v[38:39], 0
    v_mov_b64 v[40:41], 0
    v_mov_b64 v[42:43], 0
    v_mov_b64 v[44:45], 0
    v_mov_b64 v[46:47], 0
    v_mov_b64 v[48:49], 0
    v_mov_b64 v[50:51], 0
    v_mov_b64 v[52:53], 0
    v_mov_b64 v[54:55], 0
    v_mov_b64 v[56:57], 0
    v_mov_b64 v[58:59], 0
    v_mov_b64 v[60:61], 0
    v_mov_b64 v[62:63], 0
    v_mov_b32 v224, 0x3f803f80
    v_mov_b32 v225, 0x3f803f80
    v_mov_b32 v226, 0x3f803f80
    v_mov_b32 v227, 0x3f803f80
    v_mov_b64 v[228:229], 0
    v_mov_b64 v[230:231], 0
    v_mov_b64 v[232:233], 0
    v_mov_b64 v[234:235], 0
    s_mov_b32 s67, s23
    v_mov_b32 v246, v254
    s_nop 1
    v_permlane32_swap_b32 v254, v246
    v_max_f32 v254, v254, v246
    v_max_f32 v242, s68, v254
    v_sub_f32 v96, v96, v242
    v_sub_f32 v97, v97, v242
    v_sub_f32 v98, v98, v242
    v_sub_f32 v99, v99, v242
    v_sub_f32 v100, v100, v242
    v_sub_f32 v101, v101, v242
    v_sub_f32 v102, v102, v242
    v_sub_f32 v103, v103, v242
    v_sub_f32 v104, v104, v242
    v_sub_f32 v105, v105, v242
    v_sub_f32 v106, v106, v242
    v_sub_f32 v107, v107, v242
    v_sub_f32 v108, v108, v242
    v_sub_f32 v109, v109, v242
    v_sub_f32 v110, v110, v242
    v_sub_f32 v111, v111, v242
    v_sub_f32 v112, v112, v242
    v_sub_f32 v113, v113, v242
    v_sub_f32 v114, v114, v242
    v_sub_f32 v115, v115, v242
    v_sub_f32 v116, v116, v242
    v_sub_f32 v117, v117, v242
    v_sub_f32 v118, v118, v242
    v_sub_f32 v119, v119, v242
    v_sub_f32 v120, v120, v242
    v_sub_f32 v121, v121, v242
    v_sub_f32 v122, v122, v242
    v_sub_f32 v123, v123, v242
    v_sub_f32 v124, v124, v242
    v_sub_f32 v125, v125, v242
    v_sub_f32 v126, v126, v242
    v_sub_f32 v127, v127, v242
    v_sub_f32 v128, 0, v242
    v_sub_f32 v129, 0, v242
    v_sub_f32 v130, 0, v242
    v_sub_f32 v131, 0, v242
    v_sub_f32 v132, 0, v242
    v_sub_f32 v133, 0, v242
    v_sub_f32 v134, 0, v242
    v_sub_f32 v135, 0, v242
    v_sub_f32 v136, 0, v242
    v_sub_f32 v137, 0, v242
    v_sub_f32 v138, 0, v242
    v_sub_f32 v139, 0, v242
    v_sub_f32 v140, 0, v242
    v_sub_f32 v141, 0, v242
    v_sub_f32 v142, 0, v242
    v_sub_f32 v143, 0, v242
    s_branch IT_RET0
QSWAP1:
    s_lshl_b32 s3, s66, 13
    s_add_u32 s3, s3, 131072
    v_lshl_add_u32 v246, v253, 4, s3
    ds_read_b128 v[144:147], v246 offset:0
    ds_read_b128 v[148:151], v246 offset:1024
    ds_read_b128 v[152:155], v246 offset:2048
    ds_read_b128 v[156:159], v246 offset:3072
    ds_read_b128 v[160:163], v246 offset:4096
    ds_read_b128 v[164:167], v246 offset:5120
    ds_read_b128 v[168:171], v246 offset:6144
    ds_read_b128 v[172:175], v246 offset:7168
    v_mov_b64 v[128:129], 0
    v_mov_b64 v[130:131], 0
    v_mov_b64 v[132:133], 0
    v_mov_b64 v[134:135], 0
    v_mov_b64 v[136:137], 0
    v_mov_b64 v[138:139], 0
    v_mov_b64 v[140:141], 0
    v_mov_b64 v[142:143], 0
    s_waitcnt lgkmcnt(0)
    s_branch QSWAP_RET1
MASK1:
    s_nop 7
    v_mov_b32 v247, 0xff800000
    v_cmp_gt_i32 s[70:71], 0, v245
    v_cmp_gt_i32 s[72:73], 1, v245
    v_cmp_gt_i32 s[74:75], 2, v245
    v_cmp_gt_i32 s[76:77], 3, v245
    s_nop 0
    v_cndmask_b32 v64, v64, v247, s[70:71]
    v_cndmask_b32 v65, v65, v247, s[72:73]
    v_cndmask_b32 v66, v66, v247, s[74:75]
    v_cndmask_b32 v67, v67, v247, s[76:77]
    v_cmp_gt_i32 s[70:71], 4, v245
    v_cmp_gt_i32 s[72:73], 5, v245
    v_cmp_gt_i32 s[74:75], 6, v245
    v_cmp_gt_i32 s[76:77], 7, v245
    s_nop 0
    v_cndmask_b32 v68, v68, v247, s[70:71]
    v_cndmask_b32 v69, v69, v247, s[72:73]
    v_cndmask_b32 v70, v70, v247, s[74:75]
    v_cndmask_b32 v71, v71, v247, s[76:77]
    v_cmp_gt_i32 s[70:71], 16, v245
    v_cmp_gt_i32 s[72:73], 17, v245
    v_cmp_gt_i32 s[74:75], 18, v245
    v_cmp_gt_i32 s[76:77], 19, v245
    s_nop 0
    v_cndmask_b32 v72, v72, v247, s[70:71]
    v_cndmask_b32 v73, v73, v247, s[72:73]
    v_cndmask_b32 v74, v74, v247, s[74:75]
    v_cndmask_b32 v75, v75, v247, s[76:77]
    v_cmp_gt_i32 s[70:71], 20, v245
    v_cmp_gt_i32 s[72:73], 21, v245
    v_cmp_gt_i32 s[74:75], 22, v245
    v_cmp_gt_i32 s[76:77], 23, v245
    s_nop 0
    v_cndmask_b32 v76, v76, v247, s[70:71]
    v_cndmask_b32 v77, v77, v247, s[72:73]
    v_cndmask_b32 v78, v78, v247, s[74:75]
    v_cndmask_b32 v79, v79, v247, s[76:77]
    v_cmp_gt_i32 s[70:71], 32, v245
    v_cmp_gt_i32 s[72:73], 33, v245
    v_cmp_gt_i32 s[74:75], 34, v245
    v_cmp_gt_i32 s[76:77], 35, v245
    s_nop 0
    v_cndmask_b32 v80, v80, v247, s[70:71]
    v_cndmask_b32 v81, v81, v247, s[72:73]
    v_cndmask_b32 v82, v82, v247, s[74:75]
    v_cndmask_b32 v83, v83, v247, s[76:77]
    v_cmp_gt_i32 s[70:71], 36, v245
    v_cmp_gt_i32 s[72:73], 37, v245
    v_cmp_gt_i32 s[74:75], 38, v245
    v_cmp_gt_i32 s[76:77], 39, v245
    s_nop 0
    v_cndmask_b32 v84, v84, v247, s[70:71]
    v_cndmask_b32 v85, v85, v247, s[72:73]
    v_cndmask_b32 v86, v86, v247, s[74:75]
    v_cndmask_b32 v87, v87, v247, s[76:77]
    v_cmp_gt_i32 s[70:71], 48, v245
    v_cmp_gt_i32 s[72:73], 49, v245
    v_cmp_gt_i32 s[74:75], 50, v245
    v_cmp_gt_i32 s[76:77], 51, v245
    s_nop 0
    v_cndmask_b32 v88, v88, v247, s[70:71]
    v_cndmask_b32 v89, v89, v247, s[72:73]
    v_cndmask_b32 v90, v90, v247, s[74:75]
    v_cndmask_b32 v91, v91, v247, s[76:77]
    v_cmp_gt_i32 s[70:71], 52, v245
    v_cmp_gt_i32 s[72:73], 53, v245
    v_cmp_gt_i32 s[74:75], 54, v245
    v_cmp_gt_i32 s[76:77], 55, v245
    s_nop 0
    v_cndmask_b32 v92, v92, v247, s[70:71]
    v_cndmask_b32 v93, v93, v247, s[72:73]
    v_cndmask_b32 v94, v94, v247, s[74:75]
    v_cndmask_b32 v95, v95, v247, s[76:77]
    s_branch MASK_RET1
RESC1:
    v_mov_b32 v246, v254
    s_nop 1
    v_permlane32_swap_b32 v254, v246
    v_max_f32 v254, v254, v246
    v_max_f32 v254, 0, v254
    v_add_f32 v242, v242, v254
    v_exp_f32 v246, -v254
    v_sub_f32 v64, v64, v254
    v_sub_f32 v65, v65, v254
    v_sub_f32 v66, v66, v254
    v_sub_f32 v67, v67, v254
    v_sub_f32 v68, v68, v254
    v_sub_f32 v69, v69, v254
    v_sub_f32 v70, v70, v254
    v_sub_f32 v71, v71, v254
    v_sub_f32 v72, v72, v254
    v_sub_f32 v73, v73, v254
    v_sub_f32 v74, v74, v254
    v_sub_f32 v75, v75, v254
    v_sub_f32 v76, v76, v254
    v_sub_f32 v77, v77, v254
    v_sub_f32 v78, v78, v254
    v_sub_f32 v79, v79, v254
    v_sub_f32 v80, v80, v254
    v_sub_f32 v81, v81, v254
    v_sub_f32 v82, v82, v254
    v_sub_f32 v83, v83, v254
    v_sub_f32 v84, v84, v254
    v_sub_f32 v85, v85, v254
    v_sub_f32 v86, v86, v254
    v_sub_f32 v87, v87, v254
    v_sub_f32 v88, v88, v254
    v_sub_f32 v89, v89, v254
    v_sub_f32 v90, v90, v254
    v_sub_f32 v91, v91, v254
    v_sub_f32 v92, v92, v254
    v_sub_f32 v93, v93, v254
    v_sub_f32 v94, v94, v254
    v_sub_f32 v95, v95, v254
    v_sub_f32 v128, 0, v242
    v_sub_f32 v129, 0, v242
    v_sub_f32 v130, 0, v242
    v_sub_f32 v131, 0, v242
    v_sub_f32 v132, 0, v242
    v_sub_f32 v133, 0, v242
    v_sub_f32 v134, 0, v242
    v_sub_f32 v135, 0, v242
    v_sub_f32 v136, 0, v242
    v_sub_f32 v137, 0, v242
    v_sub_f32 v138, 0, v242
    v_sub_f32 v139, 0, v242
    v_sub_f32 v140, 0, v242
    v_sub_f32 v141, 0, v242
    v_sub_f32 v142, 0, v242
    v_sub_f32 v143, 0, v242
    v_mov_b32 v247, v246
    s_nop 1
    v_permlane16_swap_b32 v246, v247
    v_mul_f32 v228, v228, v246
    v_mul_f32 v229, v229, v246
    v_mul_f32 v230, v230, v246
    v_mul_f32 v231, v231, v246
    v_mul_f32 v232, v232, v247
    v_mul_f32 v233, v233, v247
    v_mul_f32 v234, v234, v247
    v_mul_f32 v235, v235, v247
    v_mul_f32 v0, v0, v246
    v_mul_f32 v1, v1, v246
    v_mul_f32 v2, v2, v246
    v_mul_f32 v3, v3, v246
    v_mul_f32 v4, v4, v246
    v_mul_f32 v5, v5, v246
    v_mul_f32 v6, v6, v246
    v_mul_f32 v7, v7, v246
    v_mul_f32 v8, v8, v247
    v_mul_f32 v9, v9, v247
    v_mul_f32 v10, v10, v247
    v_mul_f32 v11, v11, v247
    v_mul_f32 v12, v12, v247
    v_mul_f32 v13, v13, v247
    v_mul_f32 v14, v14, v247
    v_mul_f32 v15, v15, v247
    v_mul_f32 v16, v16, v246
    v_mul_f32 v17, v17, v246
    v_mul_f32 v18, v18, v246
    v_mul_f32 v19, v19, v246
    v_mul_f32 v20, v20, v246
    v_mul_f32 v21, v21, v246
    v_mul_f32 v22, v22, v246
    v_mul_f32 v23, v23, v246
    v_mul_f32 v24, v24, v247
    v_mul_f32 v25, v25, v247
    v_mul_f32 v26, v26, v247
    v_mul_f32 v27, v27, v247
    v_mul_f32 v28, v28, v247
    v_mul_f32 v29, v29, v247
    v_mul_f32 v30, v30, v247
    v_mul_f32 v31, v31, v247
    v_mul_f32 v32, v32, v246
    v_mul_f32 v33, v33, v246
    v_mul_f32 v34, v34, v246
    v_mul_f32 v35, v35, v246
    v_mul_f32 v36, v36, v246
    v_mul_f32 v37, v37, v246
    v_mul_f32 v38, v38, v246
    v_mul_f32 v39, v39, v246
    v_mul_f32 v40, v40, v247
    v_mul_f32 v41, v41, v247
    v_mul_f32 v42, v42, v247
    v_mul_f32 v43, v43, v247
    v_mul_f32 v44, v44, v247
    v_mul_f32 v45, v45, v247
    v_mul_f32 v46, v46, v247
    v_mul_f32 v47, v47, v247
    v_mul_f32 v48, v48, v246
    v_mul_f32 v49, v49, v246
    v_mul_f32 v50, v50, v246
    v_mul_f32 v51, v51, v246
    v_mul_f32 v52, v52, v246
    v_mul_f32 v53, v53, v246
    v_mul_f32 v54, v54, v246
    v_mul_f32 v55, v55, v246
    v_mul_f32 v56, v56, v247
    v_mul_f32 v57, v57, v247
    v_mul_f32 v58, v58, v247
    v_mul_f32 v59, v59, v247
    v_mul_f32 v60, v60, v247
    v_mul_f32 v61, v61, v247
    v_mul_f32 v62, v62, v247
    v_mul_f32 v63, v63, v247
    s_branch IT_RET1
BOUND1:
    s_mov_b32 s63, 1
    s_and_b32 s3, s66, 1
    s_lshl_b32 s3, s3, 13
    s_cmp_lt_u32 s66, 2
    s_mov_b32 s4, 49152
    s_cselect_b32 s4, 131072, s4
    s_mov_b32 s5, 65536
    s_cselect_b32 s5, 16384, s5
    s_add_u32 s3, s3, s4
    s_mul_i32 s4, s5, s65
    s_add_u32 s3, s3, s4
    s_mov_b32 s6, 0xffff0000
    s_mov_b32 s7, s6
    v_cndmask_b32 v243, v228, v232, s[6:7]
    v_lshl_add_u32 v248, v253, 4, s3
    v_xor_b32 v249, s5, v248
    ds_write_b64 v249, v[242:243]
    s_waitcnt lgkmcnt(0)
    s_barrier
    ds_read_b64 v[250:251], v248
    s_cmp_eq_u32 s65, 0
    s_waitcnt lgkmcnt(0)
    s_cbranch_scc1 MERGE0
    s_branch MERGE1
BOUND_RET1:
    v_mov_b64 v[0:1], 0
    v_mov_b64 v[2:3], 0
    v_mov_b64 v[4:5], 0
    v_mov_b64 v[6:7], 0
    v_mov_b64 v[8:9], 0
    v_mov_b64 v[10:11], 0
    v_mov_b64 v[12:13], 0
    v_mov_b64 v[14:15], 0
    v_mov_b64 v[16:17], 0
    v_mov_b64 v[18:19], 0
    v_mov_b64 v[20:21], 0
    v_mov_b64 v[22:23], 0
    v_mov_b64 v[24:25], 0
    v_mov_b64 v[26:27], 0
    v_mov_b64 v[28:29], 0
    v_mov_b64 v[30:31], 0
    v_mov_b64 v[32:33], 0
    v_mov_b64 v[34:35], 0
    v_mov_b64 v[36:37], 0
    v_mov_b64 v[38:39], 0
    v_mov_b64 v[40:41], 0
    v_mov_b64 v[42:43], 0
    v_mov_b64 v[44:45], 0
    v_mov_b64 v[46:47], 0
    v_mov_b64 v[48:49], 0
    v_mov_b64 v[50:51], 0
    v_mov_b64 v[52:53], 0
    v_mov_b64 v[54:55], 0
    v_mov_b64 v[56:57], 0
    v_mov_b64 v[58:59], 0
    v_mov_b64 v[60:61], 0
    v_mov_b64 v[62:63], 0
    v_mov_b32 v224, 0x3f803f80
    v_mov_b32 v225, 0x3f803f80
    v_mov_b32 v226, 0x3f803f80
    v_mov_b32 v227, 0x3f803f80
    v_mov_b64 v[228:229], 0
    v_mov_b64 v[230:231], 0
    v_mov_b64 v[232:233], 0
    v_mov_b64 v[234:235], 0
    s_mov_b32 s67, s23
    v_mov_b32 v246, v254
    s_nop 1
    v_permlane32_swap_b32 v254, v246
    v_max_f32 v254, v254, v246
    v_max_f32 v242, s68, v254
    v_sub_f32 v64, v64, v242
    v_sub_f32 v65, v65, v242
    v_sub_f32 v66, v66, v242
    v_sub_f32 v67, v67, v242
    v_sub_f32 v68, v68, v242
    v_sub_f32 v69, v69, v242
    v_sub_f32 v70, v70, v242
    v_sub_f32 v71, v71, v242
    v_sub_f32 v72, v72, v242
    v_sub_f32 v73, v73, v242
    v_sub_f32 v74, v74, v242
    v_sub_f32 v75, v75, v242
    v_sub_f32 v76, v76, v242
    v_sub_f32 v77, v77, v242
    v_sub_f32 v78, v78, v242
    v_sub_f32 v79, v79, v242
    v_sub_f32 v80, v80, v242
    v_sub_f32 v81, v81, v242
    v_sub_f32 v82, v82, v242
    v_sub_f32 v83, v83, v242
    v_sub_f32 v84, v84, v242
    v_sub_f32 v85, v85, v242
    v_sub_f32 v86, v86, v242
    v_sub_f32 v87, v87, v242
    v_sub_f32 v88, v88, v242
    v_sub_f32 v89, v89, v242
    v_sub_f32 v90, v90, v242
    v_sub_f32 v91, v91, v242
    v_sub_f32 v92, v92, v242
    v_sub_f32 v93, v93, v242
    v_sub_f32 v94, v94, v242
    v_sub_f32 v95, v95, v242
    v_sub_f32 v128, 0, v242
    v_sub_f32 v129, 0, v242
    v_sub_f32 v130, 0, v242
    v_sub_f32 v131, 0, v242
    v_sub_f32 v132, 0, v242
    v_sub_f32 v133, 0, v242
    v_sub_f32 v134, 0, v242
    v_sub_f32 v135, 0, v242
    v_sub_f32 v136, 0, v242
    v_sub_f32 v137, 0, v242
    v_sub_f32 v138, 0, v242
    v_sub_f32 v139, 0, v242
    v_sub_f32 v140, 0, v242
    v_sub_f32 v141, 0, v242
    v_sub_f32 v142, 0, v242
    v_sub_f32 v143, 0, v242
    s_branch IT_RET1
MERGE0:
    ds_write_b128 v248, v[32:35] offset:0
    ds_write_b128 v248, v[36:39] offset:1024
    ds_write_b128 v248, v[40:43] offset:2048
    ds_write_b128 v248, v[44:47] offset:3072
    ds_write_b128 v248, v[48:51] offset:4096
    ds_write_b128 v248, v[52:55] offset:5120
    ds_write_b128 v248, v[56:59] offset:6144
    ds_write_b128 v248, v[60:63] offset:7168
    v_max_f32 v246, v242, v250
    v_sub_f32 v247, v242, v246
    v_sub_f32 v250, v250, v246
    v_exp_f32 v247, v247
    v_exp_f32 v250, v250
    v_xor_b32 v248, s5, v248
    v_mul_f32 v243, v243, v247
    v_fmac_f32 v243, v251, v250
    v_rcp_f32 v243, v243
    s_waitcnt lgkmcnt(0)
    s_barrier
    ds_read_b128 v[176:179], v248 offset:0
    ds_read_b128 v[180:183], v248 offset:1024
    ds_read_b128 v[184:187], v248 offset:2048
    ds_read_b128 v[188:191], v248 offset:3072
    ds_read_b128 v[224:227], v248 offset:4096
    ds_read_b128 v[228:231], v248 offset:5120
    ds_read_b128 v[232:235], v248 offset:6144
    ds_read_b128 v[236:239], v248 offset:7168
    v_mul_f32 v247, v247, v243
    v_mul_f32 v250, v250, v243
    v_mov_b32 v246, v247
    s_nop 1
    v_permlane16_swap_b32 v247, v246
    v_mov_b32 v251, v250
    s_nop 1
    v_permlane16_swap_b32 v250, v251
    v_lshlrev_b32 v249, 4, v253
    v_mul_f32 v0, v0, v247
    v_mul_f32 v1, v1, v247
    v_mul_f32 v2, v2, v247
    v_mul_f32 v3, v3, v247
    v_mul_f32 v4, v4, v247
    v_mul_f32 v5, v5, v247
    v_mul_f32 v6, v6, v247
    v_mul_f32 v7, v7, v247
    v_mul_f32 v8, v8, v246
    v_mul_f32 v9, v9, v246
    v_mul_f32 v10, v10, v246
    v_mul_f32 v11, v11, v246
    v_mul_f32 v12, v12, v246
    v_mul_f32 v13, v13, v246
    v_mul_f32 v14, v14, v246
    v_mul_f32 v15, v15, v246
    v_mul_f32 v16, v16, v247
    v_mul_f32 v17, v17, v247
    v_mul_f32 v18, v18, v247
    v_mul_f32 v19, v19, v247
    v_mul_f32 v20, v20, v247
    v_mul_f32 v21, v21, v247
    v_mul_f32 v22, v22, v247
    v_mul_f32 v23, v23, v247
    v_mul_f32 v24, v24, v246
    v_mul_f32 v25, v25, v246
    v_mul_f32 v26, v26, v246
    v_mul_f32 v27, v27, v246
    v_mul_f32 v28, v28, v246
    v_mul_f32 v29, v29, v246
    v_mul_f32 v30, v30, v246
    v_mul_f32 v31, v31, v246
    s_lshl_b32 s3, s67, 3
    s_lshl_b32 s4, s66, 1
    s_add_u32 s3, s3, s4
    s_mul_i32 s3, s3, 182
    s_lshl_b32 s4, s22, 2
    s_add_u32 s3, s3, s4
    s_add_u32 s3, s3, 0
    s_lshl_b32 s3, s3, 10
    s_add_u32 s4, s3, 186368
    s_waitcnt lgkmcnt(6)
    v_fmac_f32 v0, v176, v250
    v_fmac_f32 v1, v177, v250
    v_fmac_f32 v2, v178, v250
    v_fmac_f32 v3, v179, v250
    v_fmac_f32 v4, v180, v250
    v_fmac_f32 v5, v181, v250
    v_fmac_f32 v6, v182, v250
    v_fmac_f32 v7, v183, v250
    v_cvt_pk_bf16_f32 v32, v0, v1
    v_cvt_pk_bf16_f32 v33, v2, v3
    v_cvt_pk_bf16_f32 v34, v4, v5
    v_cvt_pk_bf16_f32 v35, v6, v7
    buffer_store_dwordx4 v[32:35], v249, s[52:55], s3 offen offset:0 sc1
    s_waitcnt lgkmcnt(4)
    v_fmac_f32 v8, v184, v251
    v_fmac_f32 v9, v185, v251
    v_fmac_f32 v10, v186, v251
    v_fmac_f32 v11, v187, v251
    v_fmac_f32 v12, v188, v251
    v_fmac_f32 v13, v189, v251
    v_fmac_f32 v14, v190, v251
    v_fmac_f32 v15, v191, v251
    v_cvt_pk_bf16_f32 v36, v8, v9
    v_cvt_pk_bf16_f32 v37, v10, v11
    v_cvt_pk_bf16_f32 v38, v12, v13
    v_cvt_pk_bf16_f32 v39, v14, v15
    buffer_store_dwordx4 v[36:39], v249, s[52:55], s4 offen offset:0 sc1
    s_waitcnt lgkmcnt(2)
    v_fmac_f32 v16, v224, v250
    v_fmac_f32 v17, v225, v250
    v_fmac_f32 v18, v226, v250
    v_fmac_f32 v19, v227, v250
    v_fmac_f32 v20, v228, v250
    v_fmac_f32 v21, v229, v250
    v_fmac_f32 v22, v230, v250
    v_fmac_f32 v23, v231, v250
    v_cvt_pk_bf16_f32 v40, v16, v17
    v_cvt_pk_bf16_f32 v41, v18, v19
    v_cvt_pk_bf16_f32 v42, v20, v21
    v_cvt_pk_bf16_f32 v43, v22, v23
    buffer_store_dwordx4 v[40:43], v249, s[52:55], s3 offen offset:1024 sc1
    s_waitcnt lgkmcnt(0)
    s_barrier
    v_fmac_f32 v24, v232, v251
    v_fmac_f32 v25, v233, v251
    v_fmac_f32 v26, v234, v251
    v_fmac_f32 v27, v235, v251
    v_fmac_f32 v28, v236, v251
    v_fmac_f32 v29, v237, v251
    v_fmac_f32 v30, v238, v251
    v_fmac_f32 v31, v239, v251
    v_cvt_pk_bf16_f32 v44, v24, v25
    v_cvt_pk_bf16_f32 v45, v26, v27
    v_cvt_pk_bf16_f32 v46, v28, v29
    v_cvt_pk_bf16_f32 v47, v30, v31
    buffer_store_dwordx4 v[44:47], v249, s[52:55], s4 offen offset:1024 sc1
    s_nop 0
    s_branch MERGE_RET
MERGE1:
    ds_write_b128 v248, v[0:3] offset:0
    ds_write_b128 v248, v[4:7] offset:1024
    ds_write_b128 v248, v[8:11] offset:2048
    ds_write_b128 v248, v[12:15] offset:3072
    ds_write_b128 v248, v[16:19] offset:4096
    ds_write_b128 v248, v[20:23] offset:5120
    ds_write_b128 v248, v[24:27] offset:6144
    ds_write_b128 v248, v[28:31] offset:7168
    v_max_f32 v246, v242, v250
    v_sub_f32 v247, v242, v246
    v_sub_f32 v250, v250, v246
    v_exp_f32 v247, v247
    v_exp_f32 v250, v250
    v_xor_b32 v248, s5, v248
    v_mul_f32 v243, v243, v247
    v_fmac_f32 v243, v251, v250
    v_rcp_f32 v243, v243
    s_waitcnt lgkmcnt(0)
    s_barrier
    ds_read_b128 v[176:179], v248 offset:0
    ds_read_b128 v[180:183], v248 offset:1024
    ds_read_b128 v[184:187], v248 offset:2048
    ds_read_b128 v[188:191], v248 offset:3072
    ds_read_b128 v[224:227], v248 offset:4096
    ds_read_b128 v[228:231], v248 offset:5120
    ds_read_b128 v[232:235], v248 offset:6144
    ds_read_b128 v[236:239], v248 offset:7168
    v_mul_f32 v247, v247, v243
    v_mul_f32 v250, v250, v243
    v_mov_b32 v246, v247
    s_nop 1
    v_permlane16_swap_b32 v247, v246
    v_mov_b32 v251, v250
    s_nop 1
    v_permlane16_swap_b32 v250, v251
    v_lshlrev_b32 v249, 4, v253
    v_mul_f32 v32, v32, v247
    v_mul_f32 v33, v33, v247
    v_mul_f32 v34, v34, v247
    v_mul_f32 v35, v35, v247
    v_mul_f32 v36, v36, v247
    v_mul_f32 v37, v37, v247
    v_mul_f32 v38, v38, v247
    v_mul_f32 v39, v39, v247
    v_mul_f32 v40, v40, v246
    v_mul_f32 v41, v41, v246
    v_mul_f32 v42, v42, v246
    v_mul_f32 v43, v43, v246
    v_mul_f32 v44, v44, v246
    v_mul_f32 v45, v45, v246
    v_mul_f32 v46, v46, v246
    v_mul_f32 v47, v47, v246
    v_mul_f32 v48, v48, v247
    v_mul_f32 v49, v49, v247
    v_mul_f32 v50, v50, v247
    v_mul_f32 v51, v51, v247
    v_mul_f32 v52, v52, v247
    v_mul_f32 v53, v53, v247
    v_mul_f32 v54, v54, v247
    v_mul_f32 v55, v55, v247
    v_mul_f32 v56, v56, v246
    v_mul_f32 v57, v57, v246
    v_mul_f32 v58, v58, v246
    v_mul_f32 v59, v59, v246
    v_mul_f32 v60, v60, v246
    v_mul_f32 v61, v61, v246
    v_mul_f32 v62, v62, v246
    v_mul_f32 v63, v63, v246
    s_lshl_b32 s3, s67, 3
    s_lshl_b32 s4, s66, 1
    s_add_u32 s3, s3, s4
    s_mul_i32 s3, s3, 182
    s_lshl_b32 s4, s22, 2
    s_add_u32 s3, s3, s4
    s_add_u32 s3, s3, 2
    s_lshl_b32 s3, s3, 10
    s_add_u32 s4, s3, 186368
    s_waitcnt lgkmcnt(6)
    v_fmac_f32 v32, v176, v250
    v_fmac_f32 v33, v177, v250
    v_fmac_f32 v34, v178, v250
    v_fmac_f32 v35, v179, v250
    v_fmac_f32 v36, v180, v250
    v_fmac_f32 v37, v181, v250
    v_fmac_f32 v38, v182, v250
    v_fmac_f32 v39, v183, v250
    v_cvt_pk_bf16_f32 v0, v32, v33
    v_cvt_pk_bf16_f32 v1, v34, v35
    v_cvt_pk_bf16_f32 v2, v36, v37
    v_cvt_pk_bf16_f32 v3, v38, v39
    buffer_store_dwordx4 v[0:3], v249, s[52:55], s3 offen offset:0 sc1
    s_waitcnt lgkmcnt(4)
    v_fmac_f32 v40, v184, v251
    v_fmac_f32 v41, v185, v251
    v_fmac_f32 v42, v186, v251
    v_fmac_f32 v43, v187, v251
    v_fmac_f32 v44, v188, v251
    v_fmac_f32 v45, v189, v251
    v_fmac_f32 v46, v190, v251
    v_fmac_f32 v47, v191, v251
    v_cvt_pk_bf16_f32 v4, v40, v41
    v_cvt_pk_bf16_f32 v5, v42, v43
    v_cvt_pk_bf16_f32 v6, v44, v45
    v_cvt_pk_bf16_f32 v7, v46, v47
    buffer_store_dwordx4 v[4:7], v249, s[52:55], s4 offen offset:0 sc1
    s_waitcnt lgkmcnt(2)
    v_fmac_f32 v48, v224, v250
    v_fmac_f32 v49, v225, v250
    v_fmac_f32 v50, v226, v250
    v_fmac_f32 v51, v227, v250
    v_fmac_f32 v52, v228, v250
    v_fmac_f32 v53, v229, v250
    v_fmac_f32 v54, v230, v250
    v_fmac_f32 v55, v231, v250
    v_cvt_pk_bf16_f32 v8, v48, v49
    v_cvt_pk_bf16_f32 v9, v50, v51
    v_cvt_pk_bf16_f32 v10, v52, v53
    v_cvt_pk_bf16_f32 v11, v54, v55
    buffer_store_dwordx4 v[8:11], v249, s[52:55], s3 offen offset:1024 sc1
    s_waitcnt lgkmcnt(0)
    s_barrier
    v_fmac_f32 v56, v232, v251
    v_fmac_f32 v57, v233, v251
    v_fmac_f32 v58, v234, v251
    v_fmac_f32 v59, v235, v251
    v_fmac_f32 v60, v236, v251
    v_fmac_f32 v61, v237, v251
    v_fmac_f32 v62, v238, v251
    v_fmac_f32 v63, v239, v251
    v_cvt_pk_bf16_f32 v12, v56, v57
    v_cvt_pk_bf16_f32 v13, v58, v59
    v_cvt_pk_bf16_f32 v14, v60, v61
    v_cvt_pk_bf16_f32 v15, v62, v63
    buffer_store_dwordx4 v[12:15], v249, s[52:55], s4 offen offset:1024 sc1
    s_nop 0
    s_branch MERGE_RET
MERGE_RET:
    s_cmp_eq_u32 s63, 0
    s_cbranch_scc1 BOUND_RET0
    s_cmp_eq_u32 s63, 1
    s_cbranch_scc1 BOUND_RET1
K2_DONE:
    s_endpgm
.p2align 8
.globl k3_kernel
.type k3_kernel,@function
k3_kernel:
    s_cmp_ge_u32 s2, 256
    s_cbranch_scc1 K3_DONE
    s_load_dwordx2 s[36:37], s[0:1], 96
    s_load_dwordx2 s[38:39], s[0:1], 40
    s_load_dwordx4 s[40:43], s[0:1], 72
    s_load_dwordx2 s[44:45], s[0:1], 0
    v_and_b32 v112, 63, v0
    v_lshrrev_b32 v114, 6, v0
    s_bfe_u32 s24, s2, 0x20001
    v_readfirstlane_b32 s21, v114
    s_and_b32 s3, s2, 1
    s_lshl_b32 s3, s3, 3
    s_bfe_u32 s25, s2, 0x30003
    s_add_u32 s25, s25, s3
    s_lshr_b32 s26, s2, 6
    s_mul_i32 s27, s24, 23
    s_add_u32 s28, s27, 23
    s_min_u32 s28, s28, 91
    s_and_b32 s4, s21, 3
    s_cmp_lt_u32 s21, 8
    s_cbranch_scc1 K3_CONS
    s_setprio 3
    v_add_u32 v114, 0, v112
    v_mul_u32_u24 v115, 3277, v114
    v_lshrrev_b32 v115, 16, v115
    v_mul_u32_u24 v116, 20, v115
    v_sub_u32 v114, v114, v116
    v_lshrrev_b32 v116, 2, v115
    v_and_b32 v116, 2, v116
    v_xor_b32 v114, v114, v116
    v_mul_u32_u24 v115, 1280, v115
    v_lshl_add_u32 v100, v114, 4, v115
    v_add_u32 v114, 64, v112
    v_mul_u32_u24 v115, 3277, v114
    v_lshrrev_b32 v115, 16, v115
    v_mul_u32_u24 v116, 20, v115
    v_sub_u32 v114, v114, v116
    v_lshrrev_b32 v116, 2, v115
    v_and_b32 v116, 2, v116
    v_xor_b32 v114, v114, v116
    v_mul_u32_u24 v115, 1280, v115
    v_lshl_add_u32 v101, v114, 4, v115
    v_subrev_u32 v101, 1024, v101
    v_add_u32 v114, 128, v112
    v_mul_u32_u24 v115, 3277, v114
    v_lshrrev_b32 v115, 16, v115
    v_mul_u32_u24 v116, 20, v115
    v_sub_u32 v114, v114, v116
    v_lshrrev_b32 v116, 2, v115
    v_and_b32 v116, 2, v116
    v_xor_b32 v114, v114, v116
    v_mul_u32_u24 v115, 1280, v115
    v_lshl_add_u32 v102, v114, 4, v115
    v_subrev_u32 v102, 2048, v102
    v_add_u32 v114, 192, v112
    v_mul_u32_u24 v115, 3277, v114
    v_lshrrev_b32 v115, 16, v115
    v_mul_u32_u24 v116, 20, v115
    v_sub_u32 v114, v114, v116
    v_lshrrev_b32 v116, 2, v115
    v_and_b32 v116, 2, v116
    v_xor_b32 v114, v114, v116
    v_mul_u32_u24 v115, 1280, v115
    v_lshl_add_u32 v103, v114, 4, v115
    v_subrev_u32 v103, 3072, v103
    v_add_u32 v114, 256, v112
    v_mul_u32_u24 v115, 3277, v114
    v_lshrrev_b32 v115, 16, v115
    v_mul_u32_u24 v116, 20, v115
    v_sub_u32 v114, v114, v116
    v_lshrrev_b32 v116, 2, v115
    v_and_b32 v116, 2, v116
    v_xor_b32 v114, v114, v116
    v_mul_u32_u24 v115, 1280, v115
    v_lshl_add_u32 v104, v114, 4, v115
    s_mul_i32 s31, s4, 5120
    s_add_u32 s31, s31, 16384
    s_mov_b32 s30, 81920
    s_mul_i32 s5, s4, 20480
    s_mul_i32 s6, s26, 320
    s_add_u32 s34, s5, s6
    s_cmp_lt_u32 s27, 64
    s_cselect_b32 s5, 0, 64
    s_sub_u32 s5, s27, s5
    s_mul_i32 s5, s5, 81920
    s_add_u32 s29, s5, s34
    s_waitcnt lgkmcnt(0)
    s_cmp_lt_u32 s27, 64
    s_cselect_b32 s6, s38, s40
    s_cselect_b32 s7, s39, s41
    s_mov_b32 s5, 2211840
    s_cselect_b32 s5, 5242880, s5
    s_mov_b32 s8, s6
    s_and_b32 s9, s7, 0xffff
    s_mov_b32 s10, s5
    s_mov_b32 s11, 0x20000
    v_lshlrev_b32 v96, 4, v112
    v_add_u32 v97, 184320, v96
    s_lshl_b32 s60, s4, 12
    s_lshl_b32 s5, s25, 2
    s_add_u32 s5, s5, s4
    s_mul_i32 s5, s5, 182
    s_add_u32 s5, s5, s27
    s_lshl_b32 s61, s5, 11
    s_add_u32 s56, s36, 37748736
    s_addc_u32 s57, s37, 0
    s_and_b32 s57, s57, 0xffff
    s_mov_b32 s58, 23855104
    s_mov_b32 s59, 0x20000
    s_mov_b32 s33, 0
    s_mov_b32 s35, s27
    s_mov_b32 s65, 2211840
    s_add_u32 s62, s27, 4
    s_add_u32 s63, s28, 4
K3_PROD:
    s_cmp_eq_u32 s35, 64
    s_cselect_b32 s8, s40, s8
    s_cselect_b32 s9, s41, s9
    s_cselect_b32 s10, s65, s10
    s_cselect_b32 s29, s34, s29
    s_cmp_ge_u32 s35, s28
    s_cselect_b32 s10, 0, s10
    s_cselect_b32 s58, 0, s58
    s_add_u32 m0, s31, s33
    s_add_u32 s35, s35, 1
    buffer_load_dwordx4 v100, s[8:11], s29 offen offset:0 lds
    buffer_load_dwordx4 v101, s[8:11], s29 offen offset:1024 lds
    buffer_load_dwordx4 v102, s[8:11], s29 offen offset:2048 lds
    buffer_load_dwordx4 v103, s[8:11], s29 offen offset:3072 lds
    s_add_u32 m0, m0, 4096
    s_nop 0
    buffer_load_dwordx4 v104, s[8:11], s29 offen lds
    s_add_u32 m0, s60, s33
    s_add_u32 s29, s29, s30
    buffer_load_dwordx4 v96, s[56:59], s61 offen offset:0 lds
    buffer_load_dwordx4 v96, s[56:59], s61 offen offset:1024 lds
    buffer_load_dwordx4 v97, s[56:59], s61 offen offset:2048 lds
    buffer_load_dwordx4 v97, s[56:59], s61 offen offset:3072 lds
    s_add_u32 s61, s61, 2048
    s_add_u32 s33, s33, 36864
    s_cmp_eq_u32 s33, 147456
    s_cselect_b32 s33, 0, s33
    s_add_u32 s64, s27, 2
    s_cmp_eq_u32 s35, s64
    s_cbranch_scc0 K3_PR1
    s_waitcnt vmcnt(9)
    s_barrier
K3_PR1:
    s_cmp_lt_u32 s35, s62
    s_cbranch_scc1 K3_PROD
K3_PR2:
    s_cmp_eq_u32 s35, s63
    s_cbranch_scc1 K3_EPI
    s_waitcnt vmcnt(18)
    s_barrier
    s_branch K3_PROD
K3_CONS:
    s_mov_b32 s32, 0
    s_and_b32 s4, s21, 3
    s_lshl_b32 s4, s4, 12
    v_lshl_add_u32 v106, v112, 4, s4
    v_lshrrev_b32 v114, 4, v112
    v_bfe_u32 v115, v112, 2, 2
    v_lshl_add_u32 v115, v114, 3, v115
    v_mul_u32_u24 v115, 320, v115
    v_and_b32 v116, 3, v112
    v_lshl_add_u32 v115, v116, 3, v115
    v_and_b32 v114, 1, v114
    v_lshlrev_b32 v114, 5, v114
    s_lshr_b32 s4, s21, 2
    s_mul_i32 s5, s4, 160
    s_add_u32 s5, s5, 16384
    v_add_u32 v115, s5, v115
    v_add_u32 v107, v115, v114
    v_sub_u32 v108, v115, v114
    s_cmp_eq_u32 s4, 0
    s_cbranch_scc1 K3_NOSW
    v_swap_b32 v107, v108
K3_NOSW:
    v_mov_b64 v[0:1], 0
    v_mov_b64 v[2:3], 0
    v_mov_b64 v[4:5], 0
    v_mov_b64 v[6:7], 0
    v_mov_b64 v[8:9], 0
    v_mov_b64 v[10:11], 0
    v_mov_b64 v[12:13], 0
    v_mov_b64 v[14:15], 0
    v_mov_b64 v[16:17], 0
    v_mov_b64 v[18:19], 0
    v_mov_b64 v[20:21], 0
    v_mov_b64 v[22:23], 0
    v_mov_b64 v[24:25], 0
    v_mov_b64 v[26:27], 0
    v_mov_b64 v[28:29], 0
    v_mov_b64 v[30:31], 0
    v_mov_b64 v[32:33], 0
    v_mov_b64 v[34:35], 0
    v_mov_b64 v[36:37], 0
    v_mov_b64 v[38:39], 0
    v_add_u32 v109, s32, v106
    v_add_u32 v110, s32, v107
    v_add_u32 v111, s32, v108
    s_waitcnt lgkmcnt(0)
    s_barrier
    ds_read_b128 v[40:43], v109 offset:0
    ds_read_b128 v[44:47], v109 offset:2048
    ds_read_b64_tr_b16 v[56:57], v110 offset:0
    ds_read_b64_tr_b16 v[58:59], v110 offset:1280
    ds_read_b64_tr_b16 v[60:61], v111 offset:32
    ds_read_b64_tr_b16 v[62:63], v111 offset:1312
    ds_read_b64_tr_b16 v[64:65], v110 offset:64
    ds_read_b64_tr_b16 v[66:67], v110 offset:1344
    ds_read_b64_tr_b16 v[68:69], v111 offset:96
    ds_read_b64_tr_b16 v[70:71], v111 offset:1376
    ds_read_b64_tr_b16 v[72:73], v110 offset:128
    ds_read_b64_tr_b16 v[74:75], v110 offset:1408
K3_LOOP:
    s_waitcnt lgkmcnt(8)
    v_mfma_f32_16x16x32_bf16 v[0:3], v[56:59], v[40:43], v[0:3]
    ds_read_b128 v[48:51], v109 offset:1024
    ds_read_b128 v[52:55], v109 offset:3072
    v_mfma_f32_16x16x32_bf16 v[4:7], v[56:59], v[44:47], v[4:7]
    ds_read_b64_tr_b16 v[76:77], v110 offset:10240
    ds_read_b64_tr_b16 v[78:79], v110 offset:11520
    s_waitcnt lgkmcnt(10)
    v_mfma_f32_16x16x32_bf16 v[8:11], v[60:63], v[40:43], v[8:11]
    ds_read_b64_tr_b16 v[80:81], v111 offset:10272
    ds_read_b64_tr_b16 v[82:83], v111 offset:11552
    v_mfma_f32_16x16x32_bf16 v[12:15], v[60:63], v[44:47], v[12:15]
    ds_read_b64_tr_b16 v[84:85], v110 offset:10304
    ds_read_b64_tr_b16 v[86:87], v110 offset:11584
    s_waitcnt lgkmcnt(12)
    v_mfma_f32_16x16x32_bf16 v[16:19], v[64:67], v[40:43], v[16:19]
    ds_read_b64_tr_b16 v[88:89], v111 offset:10336
    ds_read_b64_tr_b16 v[90:91], v111 offset:11616
    v_mfma_f32_16x16x32_bf16 v[20:23], v[64:67], v[44:47], v[20:23]
    ds_read_b64_tr_b16 v[92:93], v110 offset:10368
    ds_read_b64_tr_b16 v[94:95], v110 offset:11648
    s_waitcnt lgkmcnt(14)
    v_mfma_f32_16x16x32_bf16 v[24:27], v[68:71], v[40:43], v[24:27]
    v_mfma_f32_16x16x32_bf16 v[28:31], v[68:71], v[44:47], v[28:31]
    s_add_u32 s32, s32, 36864
    s_cmp_eq_u32 s32, 147456
    s_cselect_b32 s32, 0, s32
    s_waitcnt lgkmcnt(12)
    v_mfma_f32_16x16x32_bf16 v[32:35], v[72:75], v[40:43], v[32:35]
    v_add_u32 v109, s32, v106
    v_add_u32 v110, s32, v107
    v_add_u32 v111, s32, v108
    v_mfma_f32_16x16x32_bf16 v[36:39], v[72:75], v[44:47], v[36:39]
    s_waitcnt lgkmcnt(0)
    s_barrier
    v_mfma_f32_16x16x32_bf16 v[0:3], v[76:79], v[48:51], v[0:3]
    ds_read_b128 v[40:43], v109 offset:0
    ds_read_b128 v[44:47], v109 offset:2048
    v_mfma_f32_16x16x32_bf16 v[4:7], v[76:79], v[52:55], v[4:7]
    ds_read_b64_tr_b16 v[56:57], v110 offset:0
    ds_read_b64_tr_b16 v[58:59], v110 offset:1280
    v_mfma_f32_16x16x32_bf16 v[8:11], v[80:83], v[48:51], v[8:11]
    ds_read_b64_tr_b16 v[60:61], v111 offset:32
    ds_read_b64_tr_b16 v[62:63], v111 offset:1312
    v_mfma_f32_16x16x32_bf16 v[12:15], v[80:83], v[52:55], v[12:15]
    ds_read_b64_tr_b16 v[64:65], v110 offset:64
    ds_read_b64_tr_b16 v[66:67], v110 offset:1344
    v_mfma_f32_16x16x32_bf16 v[16:19], v[84:87], v[48:51], v[16:19]
    ds_read_b64_tr_b16 v[68:69], v111 offset:96
    ds_read_b64_tr_b16 v[70:71], v111 offset:1376
    v_mfma_f32_16x16x32_bf16 v[20:23], v[84:87], v[52:55], v[20:23]
    ds_read_b64_tr_b16 v[72:73], v110 offset:128
    ds_read_b64_tr_b16 v[74:75], v110 offset:1408
    v_mfma_f32_16x16x32_bf16 v[24:27], v[88:91], v[48:51], v[24:27]
    v_mfma_f32_16x16x32_bf16 v[28:31], v[88:91], v[52:55], v[28:31]
    v_mfma_f32_16x16x32_bf16 v[32:35], v[92:95], v[48:51], v[32:35]
    v_mfma_f32_16x16x32_bf16 v[36:39], v[92:95], v[52:55], v[36:39]
    s_add_u32 s27, s27, 1
    s_cmp_lt_u32 s27, s28
    s_cbranch_scc1 K3_LOOP
    s_waitcnt lgkmcnt(0)
K3_EPI:
    s_waitcnt lgkmcnt(0)
    s_lshl_b32 s4, s25, 2
    s_add_u32 s4, s4, s26
    s_mul_i32 s5, s4, 163840
    s_add_u32 s5, s5, 62914560
    s_add_u32 s12, s36, s5
    s_addc_u32 s13, s37, 0
    s_and_b32 s13, s13, 0xffff
    s_mov_b32 s14, 163840
    s_mov_b32 s15, 0x20000
    v_lshlrev_b32 v114, 4, v112
    s_mul_i32 s5, s21, 5120
    s_mul_i32 s6, s24, 40960
    s_add_u32 s6, s6, s5
    s_add_u32 s5, s6, 4096
    s_cmp_lt_u32 s21, 8
    s_cbranch_scc0 K3_NOST
    v_cvt_pk_bf16_f32 v40, v0, v1
    v_cvt_pk_bf16_f32 v41, v2, v3
    v_cvt_pk_bf16_f32 v42, v4, v5
    v_cvt_pk_bf16_f32 v43, v6, v7
    buffer_store_dwordx4 v[40:43], v114, s[12:15], s6 offen offset:0 sc1
    v_cvt_pk_bf16_f32 v44, v8, v9
    v_cvt_pk_bf16_f32 v45, v10, v11
    v_cvt_pk_bf16_f32 v46, v12, v13
    v_cvt_pk_bf16_f32 v47, v14, v15
    buffer_store_dwordx4 v[44:47], v114, s[12:15], s6 offen offset:1024 sc1
    v_cvt_pk_bf16_f32 v48, v16, v17
    v_cvt_pk_bf16_f32 v49, v18, v19
    v_cvt_pk_bf16_f32 v50, v20, v21
    v_cvt_pk_bf16_f32 v51, v22, v23
    buffer_store_dwordx4 v[48:51], v114, s[12:15], s6 offen offset:2048 sc1
    v_cvt_pk_bf16_f32 v52, v24, v25
    v_cvt_pk_bf16_f32 v53, v26, v27
    v_cvt_pk_bf16_f32 v54, v28, v29
    v_cvt_pk_bf16_f32 v55, v30, v31
    buffer_store_dwordx4 v[52:55], v114, s[12:15], s6 offen offset:3072 sc1
    v_cvt_pk_bf16_f32 v56, v32, v33
    v_cvt_pk_bf16_f32 v57, v34, v35
    v_cvt_pk_bf16_f32 v58, v36, v37
    v_cvt_pk_bf16_f32 v59, v38, v39
    buffer_store_dwordx4 v[56:59], v114, s[12:15], s5 offen offset:0 sc1
K3_NOST:
    s_add_u32 s16, s36, 3145728
    s_addc_u32 s17, s37, 0
    s_and_b32 s17, s17, 0xffff
    s_mov_b32 s18, 16384
    s_mov_b32 s19, 0x20000
    s_lshl_b32 s7, s4, 8
    v_mov_b32 v117, 0
    v_mov_b32 v118, 1
    s_waitcnt vmcnt(0)
    s_barrier
    s_cmp_eq_u32 s21, 0
    s_cbranch_scc0 K3_NOAT
    s_mov_b64 exec, 1
    buffer_atomic_add v118, v117, s[16:19], s7 offen sc0 sc1
    s_lshl_b32 s50, 1, s24
    s_mov_b32 s48, 200
    s_waitcnt vmcnt(0)
    v_readfirstlane_b32 s5, v118
    s_and_b32 s6, s5, 7
    s_cmp_eq_u32 s6, 3
    s_cbranch_scc0 K3_POLL
    s_lshr_b32 s5, s5, 8
    s_or_b32 s50, s50, s5
    s_branch K3_PUB
K3_POLL:
    s_cmp_eq_u32 s48, 0
    s_cbranch_scc1 K3_GIVEUP
    s_sub_u32 s48, s48, 1
    s_sleep 2
    buffer_load_dword v118, v117, s[16:19], s7 offen sc0 sc1
    s_waitcnt vmcnt(0)
    v_readfirstlane_b32 s5, v118
    s_and_b32 s6, s5, 7
    s_cmp_eq_u32 s6, 4
    s_cbranch_scc0 K3_POLL
    s_branch K3_PUB
K3_GIVEUP:
    s_lshl_b32 s5, s50, 8
    v_mov_b32 v118, s5
    buffer_atomic_or v118, v117, s[16:19], s7 offen sc0 sc1
    s_waitcnt vmcnt(0)
    v_readfirstlane_b32 s5, v118
    s_and_b32 s6, s5, 7
    s_cmp_eq_u32 s6, 4
    s_cselect_b32 s50, s50, 0
K3_PUB:
    v_mov_b32 v118, s50
    ds_write_b32 v117, v118
    s_waitcnt lgkmcnt(0)
    s_mov_b64 exec, -1
K3_NOAT:
    s_mov_b32 s16, s44
    s_and_b32 s17, s45, 0xffff
    s_mov_b32 s18, 2621440
    s_mov_b32 s19, 0x20000
    s_mov_b32 s52, s42
    s_and_b32 s53, s43, 0xffff
    s_mov_b32 s54, 2621440
    s_mov_b32 s55, 0x20000
    v_and_b32 v119, 15, v112
    v_mul_u32_u24 v119, 1280, v119
    v_lshrrev_b32 v120, 4, v112
    v_lshl_add_u32 v119, v120, 3, v119
    v_add_u32 v120, 20480, v119
    s_barrier
    ds_read_b32 v118, v117
    s_waitcnt lgkmcnt(0)
    v_readfirstlane_b32 s50, v118
    s_cmp_lt_u32 s21, 10
    s_cbranch_scc0 K3_DONE
K3_QL:
    s_cmp_eq_u32 s50, 0
    s_cbranch_scc1 K3_FIN
    s_ff1_i32_b32 s51, s50
    s_bitset0_b32 s50, s51
    s_mov_b32 s65, s21
K3_PL:
    s_mul_i32 s5, s51, 10
    s_add_u32 s5, s5, s65
    s_lshl_b32 s5, s5, 10
    buffer_load_dwordx4 v[128:131], v114, s[12:15], s5 offen sc1
    s_add_u32 s5, s5, 40960
    buffer_load_dwordx4 v[132:135], v114, s[12:15], s5 offen sc1
    s_add_u32 s5, s5, 40960
    buffer_load_dwordx4 v[136:139], v114, s[12:15], s5 offen sc1
    s_add_u32 s5, s5, 40960
    buffer_load_dwordx4 v[140:143], v114, s[12:15], s5 offen sc1
    s_cmp_ge_u32 s65, 5
    s_cselect_b32 s6, 1, 0
    s_cselect_b32 s7, 5, 0
    s_sub_u32 s7, s65, s7
    s_lshl_b32 s5, s51, 1
    s_add_u32 s6, s6, s5
    s_lshl_b32 s4, s25, 2
    s_and_b32 s5, s6, 3
    s_add_u32 s4, s4, s5
    s_mul_i32 s4, s4, 40960
    s_mul_i32 s5, s26, 320
    s_add_u32 s4, s4, s5
    s_lshr_b32 s5, s6, 2
    s_mul_i32 s5, s5, 160
    s_add_u32 s4, s4, s5
    s_lshl_b32 s5, s7, 5
    s_add_u32 s4, s4, s5
    buffer_load_dwordx2 v[144:145], v119, s[16:19], s4 offen
    buffer_load_dwordx2 v[146:147], v120, s[16:19], s4 offen
    s_waitcnt vmcnt(0)
    v_lshlrev_b32 v0, 16, v144
    v_and_b32 v1, 0xffff0000, v144
    v_lshlrev_b32 v8, 16, v128
    v_and_b32 v9, 0xffff0000, v128
    v_add_f32 v0, v0, v8
    v_add_f32 v1, v1, v9
    v_lshlrev_b32 v8, 16, v132
    v_and_b32 v9, 0xffff0000, v132
    v_add_f32 v0, v0, v8
    v_add_f32 v1, v1, v9
    v_lshlrev_b32 v8, 16, v136
    v_and_b32 v9, 0xffff0000, v136
    v_add_f32 v0, v0, v8
    v_add_f32 v1, v1, v9
    v_lshlrev_b32 v8, 16, v140
    v_and_b32 v9, 0xffff0000, v140
    v_add_f32 v0, v0, v8
    v_add_f32 v1, v1, v9
    v_cvt_pk_bf16_f32 v10, v0, v1
    v_lshlrev_b32 v2, 16, v145
    v_and_b32 v3, 0xffff0000, v145
    v_lshlrev_b32 v8, 16, v129
    v_and_b32 v9, 0xffff0000, v129
    v_add_f32 v2, v2, v8
    v_add_f32 v3, v3, v9
    v_lshlrev_b32 v8, 16, v133
    v_and_b32 v9, 0xffff0000, v133
    v_add_f32 v2, v2, v8
    v_add_f32 v3, v3, v9
    v_lshlrev_b32 v8, 16, v137
    v_and_b32 v9, 0xffff0000, v137
    v_add_f32 v2, v2, v8
    v_add_f32 v3, v3, v9
    v_lshlrev_b32 v8, 16, v141
    v_and_b32 v9, 0xffff0000, v141
    v_add_f32 v2, v2, v8
    v_add_f32 v3, v3, v9
    v_cvt_pk_bf16_f32 v11, v2, v3
    v_lshlrev_b32 v4, 16, v146
    v_and_b32 v5, 0xffff0000, v146
    v_lshlrev_b32 v8, 16, v130
    v_and_b32 v9, 0xffff0000, v130
    v_add_f32 v4, v4, v8
    v_add_f32 v5, v5, v9
    v_lshlrev_b32 v8, 16, v134
    v_and_b32 v9, 0xffff0000, v134
    v_add_f32 v4, v4, v8
    v_add_f32 v5, v5, v9
    v_lshlrev_b32 v8, 16, v138
    v_and_b32 v9, 0xffff0000, v138
    v_add_f32 v4, v4, v8
    v_add_f32 v5, v5, v9
    v_lshlrev_b32 v8, 16, v142
    v_and_b32 v9, 0xffff0000, v142
    v_add_f32 v4, v4, v8
    v_add_f32 v5, v5, v9
    v_cvt_pk_bf16_f32 v12, v4, v5
    v_lshlrev_b32 v6, 16, v147
    v_and_b32 v7, 0xffff0000, v147
    v_lshlrev_b32 v8, 16, v131
    v_and_b32 v9, 0xffff0000, v131
    v_add_f32 v6, v6, v8
    v_add_f32 v7, v7, v9
    v_lshlrev_b32 v8, 16, v135
    v_and_b32 v9, 0xffff0000, v135
    v_add_f32 v6, v6, v8
    v_add_f32 v7, v7, v9
    v_lshlrev_b32 v8, 16, v139
    v_and_b32 v9, 0xffff0000, v139
    v_add_f32 v6, v6, v8
    v_add_f32 v7, v7, v9
    v_lshlrev_b32 v8, 16, v143
    v_and_b32 v9, 0xffff0000, v143
    v_add_f32 v6, v6, v8
    v_add_f32 v7, v7, v9
    v_cvt_pk_bf16_f32 v13, v6, v7
    buffer_store_dwordx2 v[10:11], v119, s[52:55], s4 offen
    buffer_store_dwordx2 v[12:13], v120, s[52:55], s4 offen
    s_branch K3_QL
K3_FIN:
K3_DONE:
    s_endpgm
.section .rodata,"a"
.p2align 6
.amdhsa_kernel k1_kernel
  .amdhsa_next_free_vgpr 256
  .amdhsa_next_free_sgpr 96
  .amdhsa_accum_offset 256
  .amdhsa_group_segment_fixed_size 0
  .amdhsa_kernarg_size 104
  .amdhsa_user_sgpr_count 2
  .amdhsa_user_sgpr_kernarg_segment_ptr 1
  .amdhsa_system_sgpr_workgroup_id_x 1
.end_amdhsa_kernel
.p2align 6
.amdhsa_kernel k2_kernel
  .amdhsa_next_free_vgpr 256
  .amdhsa_next_free_sgpr 96
  .amdhsa_accum_offset 256
  .amdhsa_group_segment_fixed_size 0
  .amdhsa_kernarg_size 104
  .amdhsa_user_sgpr_count 2
  .amdhsa_user_sgpr_kernarg_segment_ptr 1
  .amdhsa_system_sgpr_workgroup_id_x 1
.end_amdhsa_kernel
.p2align 6
.amdhsa_kernel k3_kernel
  .amdhsa_next_free_vgpr 160
  .amdhsa_next_free_sgpr 96
  .amdhsa_accum_offset 160
  .amdhsa_group_segment_fixed_size 0
  .amdhsa_kernarg_size 104
  .amdhsa_user_sgpr_count 2
  .amdhsa_user_sgpr_kernarg_segment_ptr 1
  .amdhsa_system_sgpr_workgroup_id_x 1
.end_amdhsa_kernel
```
